```python
import torch

def _softmax(x, axis=-1):
    return torch.softmax(x, dim=axis)
def _gelu(x):
    return torch.nn.functional.gelu(x, approximate="tanh")
def _silu(x):
    return torch.nn.functional.silu(x)
def _sigmoid(x):
    return torch.sigmoid(x)
def _layernorm(x, axis=-1, eps=1e-5):
    m = x.mean(dim=axis, keepdim=True)
    v = x.var(dim=axis, keepdim=True, unbiased=False)
    return (x - m) / torch.sqrt(v + eps)
def _scatter_add(tgt, idx, src, axis=0):
    return tgt.clone().index_add_(axis, idx, src)
def _segment_sum(src, seg, n):
    out = torch.zeros((n,) + src.shape[1:], dtype=src.dtype)
    return out.index_add_(0, seg, src)
def _pad(x, pw):
    flat = tuple(v for pair in reversed(pw) for v in pair)
    return torch.nn.functional.pad(x, flat)

kernel_name = 'parallel_sum__mha_block_cached__swiglu_ffn__decode'

def setup_inputs():

    _w = (lambda a: (lambda t: t.to(torch.bfloat16) if t.is_floating_point() else t)(torch.as_tensor(a)))
    def _A_setup():
        B, Sq, D = 1, 1, 640
        H, Sk, Dh = 32, 16384, 128
        return {
            "x": _w((lambda *s: torch.randn(*s, dtype=torch.bfloat16) * 0.05)(B, Sq, D)),
            "k_cache": _w((lambda *s: torch.randn(*s, dtype=torch.bfloat16) * 3.2)(B, H, Sk, Dh)),
            "v_cache": _w((lambda *s: torch.randn(*s, dtype=torch.bfloat16) * 1.6)(B, H, Sk, Dh)),
            "wq": _w((lambda *s: torch.randn(*s, dtype=torch.bfloat16) * 3.2)(D, H * Dh) * (D ** -0.5)),
            "wo": _w((lambda *s: torch.randn(*s, dtype=torch.bfloat16) * 1.6)(H * Dh, D) * ((H * Dh) ** -0.5)),
        }
    _A_in = _A_setup()

    def _B_setup():
        B, S, D, F = 1, 1, 640, 1728
        return {
            "x": _w((lambda *s: torch.randn(*s, dtype=torch.bfloat16) * 0.05)(B, S, D)),
            "w_gate": _w((lambda *s: torch.randn(*s, dtype=torch.bfloat16) * 0.05)(D, F)),
            "w_up": _w((lambda *s: torch.randn(*s, dtype=torch.bfloat16) * 0.05)(D, F)),
            "w_down": _w((lambda *s: torch.randn(*s, dtype=torch.bfloat16) * 0.05)(F, D)),
        }
    _B_in = _B_setup()

    return {
        "A_x": _A_in["x"],
        "A_k_cache": _A_in["k_cache"],
        "A_v_cache": _A_in["v_cache"],
        "A_wq": _A_in["wq"],
        "A_wo": _A_in["wo"],
        "B_x": _B_in["x"],
        "B_w_gate": _B_in["w_gate"],
        "B_w_up": _B_in["w_up"],
        "B_w_down": _B_in["w_down"],
    }

def reference(A_x, A_k_cache, A_v_cache, A_wq, A_wo, B_x, B_w_gate, B_w_up, B_w_down):
    def _A_ref(x, k_cache, v_cache, wq, wo):
        B, Sq, D = x.shape
        H, Dh = 32, 128
        q = (lambda x, *d: x.permute(*d))((x @ wq).reshape(B, Sq, H, Dh), 0, 2, 1, 3)
        scores = torch.einsum("bhqd,bhkd->bhqk", q, k_cache) * (Dh ** -0.5)
        p = _softmax(scores, axis=-1)
        o = torch.einsum("bhqk,bhkd->bhqd", p, v_cache)
        return (lambda x, *d: x.permute(*d))(o, 0, 2, 1, 3).reshape(B, Sq, H * Dh) @ wo

    def _B_ref(x, w_gate, w_up, w_down):
        g = _silu(x @ w_gate)
        u = x @ w_up
        return (g * u) @ w_down

    x = A_x
    xn = _layernorm(x, axis=-1)
    return x + _A_ref(xn, A_k_cache, A_v_cache, A_wq, A_wo) + _B_ref(xn, B_w_gate, B_w_up, B_w_down)
```

```asm
; @launch grid=(256,1,1) block=(256,1,1) lds=19456
.amdgcn_target "amdgcn-amd-amdhsa--gfx950"
.text
.globl parallel_sum__mha_block_cached__swiglu_ffn__decode_kernel
.p2align 8
.type parallel_sum__mha_block_cached__swiglu_ffn__decode_kernel,@function
parallel_sum__mha_block_cached__swiglu_ffn__decode_kernel:
    s_load_dwordx16 s[4:19], s[0:1], 0
    s_load_dwordx8 s[20:27], s[0:1], 64
    s_cmp_ge_u32 s2, 256
    s_cbranch_scc1 L_end
    v_lshrrev_b32 v26, 6, v0
    v_and_b32 v1, 63, v0
    v_bfe_u32 v2, v0, 4, 2
    v_readfirstlane_b32 s72, v26
    v_and_b32 v3, 15, v0
    v_lshlrev_b32 v4, 4, v0
    s_and_b32 s76, s2, 7
    s_lshr_b32 s77, s2, 6
    s_lshl_b32 s74, s77, 17
    s_lshl2_add_u32 s73, s76, s77
    s_lshl3_add_u32 s80, s77, s76
    s_bfe_u32 s87, s2, 0x30003
    s_lshl3_add_u32 s83, s73, s87
    s_lshl3_add_u32 s81, s80, s87
    s_mul_i32 s78, s87, 80
    s_mul_i32 s79, s72, 20
    s_add_u32 s78, s78, s79
    v_mul_u32_u24 v28, 20, v1
    v_add_u32 v25, s78, v2
    v_and_b32 v29, 12, v0
    v_add_lshl_u32 v29, v29, v25, 1
    v_lshlrev_b32 v30, 1, v25
    v_lshlrev_b32 v31, 13, v25
    v_lshl_add_u32 v31, v3, 4, v31
    v_mul_u32_u24 v32, 3456, v25
    v_and_b32 v26, 7, v0
    v_lshl_add_u32 v32, v26, 4, v32
    s_lshl_b32 s76, s83, 19
    s_lshl_b32 s77, s73, 8
    s_lshl_b32 s78, s80, 7
    s_cmp_lt_u32 s80, 27
    s_cselect_b32 s79, 2208512, 0
    s_waitcnt lgkmcnt(0)
    s_mov_b32 s44, s4
    s_mov_b32 s45, s5
    s_mov_b32 s46, 1280
    s_mov_b32 s47, 0x20000
    buffer_load_dwordx4 v[34:37], v28, s[44:47], 0 offen
    buffer_load_dword v38, v28, s[44:47], 0 offen offset:16
    buffer_load_ushort v39, v29, s[44:47], 0 offen
    buffer_load_ushort v40, v30, s[44:47], 0 offen offset:32
    s_add_u32 s36, s10, s77
    s_addc_u32 s37, s11, 0
    s_mov_b32 s38, 5234944
    s_mov_b32 s39, 0x20000
    buffer_load_dwordx4 a[128:131], v31, s[36:39], 0 offen nt
    s_mov_b32 s77, 32768
    buffer_load_dwordx4 a[132:135], v31, s[36:39], s77 offen nt
    s_mov_b32 s77, 65536
    buffer_load_dwordx4 a[136:139], v31, s[36:39], s77 offen nt
    s_mov_b32 s77, 98304
    buffer_load_dwordx4 a[140:143], v31, s[36:39], s77 offen nt
    s_mov_b32 s77, 131072
    buffer_load_dwordx4 a[144:147], v31, s[36:39], s77 offen nt
    s_mov_b32 s52, s26
    s_mov_b32 s53, s27
    s_mov_b32 s54, 1290240
    s_mov_b32 s55, 0x20000
    s_mov_b32 s77, 1064960
    buffer_load_dword v23, off, s[52:55], s77 sc1
    s_add_u32 s28, s6, s76
    s_addc_u32 s29, s7, 0
    s_mov_b32 s30, 524288
    s_mov_b32 s31, 0x20000
    s_mov_b32 s75, s74
    buffer_load_dwordx4 v[128:131], v4, s[28:31], s75 offen nt
    s_add_u32 s75, s75, 0x1000
    buffer_load_dwordx4 v[132:135], v4, s[28:31], s75 offen nt
    s_add_u32 s75, s75, 0x1000
    buffer_load_dwordx4 v[136:139], v4, s[28:31], s75 offen nt
    s_add_u32 s75, s75, 0x1000
    buffer_load_dwordx4 v[140:143], v4, s[28:31], s75 offen nt
    s_add_u32 s64, s16, s78
    s_addc_u32 s65, s17, 0
    s_mov_b32 s66, s79
    s_mov_b32 s67, 0x20000
    s_add_u32 s68, s18, s78
    s_addc_u32 s69, s19, 0
    s_mov_b32 s70, s79
    s_mov_b32 s71, 0x20000
    s_mov_b32 exec_lo, 0x00ff00ff
    s_mov_b32 exec_hi, 0x00ff00ff
    buffer_load_dwordx4 a[148:151], v32, s[64:67], 0 offen nt
    s_mov_b32 s77, 13824
    buffer_load_dwordx4 a[152:155], v32, s[64:67], s77 offen nt
    s_mov_b32 s77, 27648
    buffer_load_dwordx4 a[156:159], v32, s[64:67], s77 offen nt
    s_mov_b32 s77, 41472
    buffer_load_dwordx4 a[160:163], v32, s[64:67], s77 offen nt
    s_mov_b32 s77, 55296
    buffer_load_dwordx4 a[164:167], v32, s[64:67], s77 offen nt
    s_mov_b32 exec_lo, 0xff00ff00
    s_mov_b32 exec_hi, 0xff00ff00
    buffer_load_dwordx4 a[148:151], v32, s[68:71], 0 offen nt
    s_mov_b32 s77, 13824
    buffer_load_dwordx4 a[152:155], v32, s[68:71], s77 offen nt
    s_mov_b32 s77, 27648
    buffer_load_dwordx4 a[156:159], v32, s[68:71], s77 offen nt
    s_mov_b32 s77, 41472
    buffer_load_dwordx4 a[160:163], v32, s[68:71], s77 offen nt
    s_mov_b32 s77, 55296
    buffer_load_dwordx4 a[164:167], v32, s[68:71], s77 offen nt
    s_mov_b64 exec, -1
    s_add_u32 s75, s75, 0x1000
    buffer_load_dwordx4 v[144:147], v4, s[28:31], s75 offen nt
    s_add_u32 s75, s75, 0x1000
    buffer_load_dwordx4 v[148:151], v4, s[28:31], s75 offen nt
    s_add_u32 s75, s75, 0x1000
    buffer_load_dwordx4 v[152:155], v4, s[28:31], s75 offen nt
    s_add_u32 s75, s75, 0x1000
    buffer_load_dwordx4 v[156:159], v4, s[28:31], s75 offen nt
    s_add_u32 s32, s8, s76
    s_addc_u32 s33, s9, 0
    s_mov_b32 s34, 524288
    s_mov_b32 s35, 0x20000
    v_mov_b32 v80, 0
    v_mov_b32 v81, 0
    v_mov_b32 v82, 0
    v_mov_b32 v83, 0
    v_mov_b32 v84, 0
    v_mov_b32 v85, 0
    v_mov_b32 v86, 0
    v_mov_b32 v87, 0
    v_and_b32 v26, 1, v0
    v_cmp_eq_u32 vcc, 1, v26
    v_mov_b32 v26, 0x0c0c0302
    v_mov_b32 v27, 0x03020c0c
    v_cndmask_b32 v10, v26, v27, vcc
    v_bfe_i32 v9, v0, 1, 1
    v_lshlrev_b32 v9, 16, v9
    v_mov_b32 v24, 1073741824
    v_lshlrev_b32 v13, 5, v3
    v_lshl_add_u32 v13, v2, 3, v13
    s_lshl_b32 s78, s72, 9
    v_add_u32 v8, s78, v13
    s_waitcnt vmcnt(24)
    v_lshlrev_b32 v96, 16, v34
    v_and_b32 v97, 0xffff0000, v34
    v_lshlrev_b32 v98, 16, v35
    v_and_b32 v99, 0xffff0000, v35
    v_lshlrev_b32 v100, 16, v36
    v_and_b32 v101, 0xffff0000, v36
    v_lshlrev_b32 v102, 16, v37
    v_and_b32 v103, 0xffff0000, v37
    v_lshlrev_b32 v104, 16, v38
    v_and_b32 v105, 0xffff0000, v38
    s_add_u32 s75, s75, 0x1000
    buffer_load_dwordx4 v[160:163], v4, s[28:31], s75 offen nt
    v_pk_add_f32 v[106:107], v[96:97], v[98:99]
    v_pk_add_f32 v[108:109], v[100:101], v[102:103]
    v_pk_add_f32 v[106:107], v[106:107], v[104:105]
    v_pk_add_f32 v[106:107], v[106:107], v[108:109]
    v_add_f32 v106, v106, v107
    s_nop 1
    v_add_f32_dpp v106, v106, v106 row_ror:8 row_mask:0xf bank_mask:0xf
    s_nop 1
    v_add_f32_dpp v106, v106, v106 row_ror:4 row_mask:0xf bank_mask:0xf
    s_nop 1
    v_add_f32_dpp v106, v106, v106 row_ror:2 row_mask:0xf bank_mask:0xf
    s_nop 1
    v_add_f32_dpp v106, v106, v106 row_ror:1 row_mask:0xf bank_mask:0xf
    s_nop 1
    v_add_f32_dpp v106, v106, v106 row_bcast:15 row_mask:0xa bank_mask:0xf
    s_add_u32 s75, s75, 0x1000
    buffer_load_dwordx4 v[164:167], v4, s[28:31], s75 offen nt
    v_add_f32_dpp v106, v106, v106 row_bcast:31 row_mask:0xc bank_mask:0xf
    s_nop 0
    v_readlane_b32 s76, v106, 63
    v_mov_b32 v110, 0xbacccccd
    s_nop 0
    v_mul_f32 v110, s76, v110
    v_mov_b32 v111, v110
    v_pk_add_f32 v[96:97], v[96:97], v[110:111]
    v_pk_add_f32 v[98:99], v[98:99], v[110:111]
    v_pk_add_f32 v[100:101], v[100:101], v[110:111]
    v_pk_add_f32 v[102:103], v[102:103], v[110:111]
    v_pk_add_f32 v[104:105], v[104:105], v[110:111]
    s_add_u32 s75, s75, 0x1000
    buffer_load_dwordx4 v[168:171], v4, s[28:31], s75 offen nt
    v_pk_mul_f32 v[106:107], v[96:97], v[96:97]
    v_pk_fma_f32 v[106:107], v[98:99], v[98:99], v[106:107]
    v_pk_fma_f32 v[106:107], v[100:101], v[100:101], v[106:107]
    v_pk_fma_f32 v[106:107], v[102:103], v[102:103], v[106:107]
    v_pk_fma_f32 v[106:107], v[104:105], v[104:105], v[106:107]
    v_add_f32 v106, v106, v107
    s_nop 1
    v_add_f32_dpp v106, v106, v106 row_ror:8 row_mask:0xf bank_mask:0xf
    s_nop 1
    v_add_f32_dpp v106, v106, v106 row_ror:4 row_mask:0xf bank_mask:0xf
    s_nop 1
    v_add_f32_dpp v106, v106, v106 row_ror:2 row_mask:0xf bank_mask:0xf
    s_nop 1
    v_add_f32_dpp v106, v106, v106 row_ror:1 row_mask:0xf bank_mask:0xf
    s_add_u32 s75, s75, 0x1000
    buffer_load_dwordx4 v[172:175], v4, s[28:31], s75 offen nt
    v_add_f32_dpp v106, v106, v106 row_bcast:15 row_mask:0xa bank_mask:0xf
    s_nop 1
    v_add_f32_dpp v106, v106, v106 row_bcast:31 row_mask:0xc bank_mask:0xf
    s_nop 0
    v_readlane_b32 s76, v106, 63
    v_cvt_pk_bf16_f32 v110, v110, v110
    v_and_b32 v110, 0xffff0000, v110
    v_mov_b32 v112, 0x3acccccd
    v_mul_f32 v112, s76, v112
    v_cvt_pk_bf16_f32 v112, v112, v112
    v_and_b32 v112, 0xffff0000, v112
    v_add_f32 v112, 0x3727c5ac, v112
    s_add_u32 s75, s75, 0x1000
    buffer_load_dwordx4 v[176:179], v4, s[28:31], s75 offen nt
    v_cvt_pk_bf16_f32 v112, v112, v112
    v_and_b32 v112, 0xffff0000, v112
    v_sqrt_f32 v112, v112
    v_lshlrev_b32 v96, 16, v39
    v_add_f32 v96, v96, v110
    v_lshlrev_b32 v97, 16, v40
    v_add_f32 v97, v97, v110
    v_cvt_pk_bf16_f32 v112, v112, v112
    v_and_b32 v112, 0xffff0000, v112
    v_rcp_f32 v113, v112
    s_add_u32 s75, s75, 0x1000
    buffer_load_dwordx4 v[180:183], v4, s[28:31], s75 offen nt
    v_cvt_pk_bf16_f32 v96, v96, v96
    v_and_b32 v96, 0xffff0000, v96
    v_cvt_pk_bf16_f32 v97, v97, v97
    v_and_b32 v97, 0xffff0000, v97
    v_mul_f32 v98, v96, v113
    v_mul_f32 v99, v97, v113
    v_fma_f32 v96, -v98, v112, v96
    v_fma_f32 v97, -v99, v112, v97
    v_fma_f32 v98, v96, v113, v98
    v_fma_f32 v99, v97, v113, v99
    s_add_u32 s75, s75, 0x1000
    buffer_load_dwordx4 v[184:187], v4, s[28:31], s75 offen nt
    v_cvt_pk_bf16_f32 v98, v98, v98
    v_and_b32 v98, 0xffff0000, v98
    v_cvt_pk_bf16_f32 v99, v99, v99
    v_and_b32 v99, 0xffff0000, v99
    v_and_b32 v96, v98, v9
    v_sub_f32 v96, v98, v96
    v_perm_b32 v18, v96, v96, v10
    v_and_b32 v97, v99, v9
    v_sub_f32 v97, v99, v97
    v_perm_b32 v19, v97, v97, v10
    s_add_u32 s75, s75, 0x1000
    buffer_load_dwordx4 v[188:191], v4, s[28:31], s75 offen nt
    v_mov_b32_dpp v80, v18 quad_perm:[0,1,2,3] row_mask:0xf bank_mask:0x1
    v_mov_b32_dpp v81, v18 row_shr:4 row_mask:0xf bank_mask:0x2
    v_mov_b32_dpp v82, v18 row_shr:8 row_mask:0xf bank_mask:0x4
    v_mov_b32_dpp v83, v18 row_shr:12 row_mask:0xf bank_mask:0x8
    s_waitcnt vmcnt(26)
    v_mov_b32_dpp v84, v18 row_shl:4 row_mask:0xf bank_mask:0x1
    v_mov_b32_dpp v85, v18 quad_perm:[0,1,2,3] row_mask:0xf bank_mask:0x2
    v_mov_b32_dpp v86, v18 row_shr:4 row_mask:0xf bank_mask:0x4
    v_mov_b32_dpp v87, v18 row_shr:8 row_mask:0xf bank_mask:0x8
    v_mfma_f32_16x16x32_bf16 v[44:47], v[80:83], a[128:131], 0
    v_mov_b32_dpp v80, v18 row_shl:8 row_mask:0xf bank_mask:0x1
    s_add_u32 s75, s75, 0x1000
    buffer_load_dwordx4 v[192:195], v4, s[28:31], s75 offen nt
    v_mov_b32_dpp v81, v18 row_shl:4 row_mask:0xf bank_mask:0x2
    v_mov_b32_dpp v82, v18 quad_perm:[0,1,2,3] row_mask:0xf bank_mask:0x4
    v_mov_b32_dpp v83, v18 row_shr:4 row_mask:0xf bank_mask:0x8
    v_mfma_f32_16x16x32_bf16 v[44:47], v[84:87], a[132:135], v[44:47]
    v_mov_b32_dpp v84, v18 row_shl:12 row_mask:0xf bank_mask:0x1
    v_mov_b32_dpp v85, v18 row_shl:8 row_mask:0xf bank_mask:0x2
    v_mov_b32_dpp v86, v18 row_shl:4 row_mask:0xf bank_mask:0x4
    v_mov_b32_dpp v87, v18 quad_perm:[0,1,2,3] row_mask:0xf bank_mask:0x8
    v_mfma_f32_16x16x32_bf16 v[44:47], v[80:83], a[136:139], v[44:47]
    v_mov_b32_dpp v80, v19 quad_perm:[0,1,2,3] row_mask:0xf bank_mask:0x1
    s_add_u32 s75, s75, 0x1000
    buffer_load_dwordx4 v[196:199], v4, s[28:31], s75 offen nt
    v_mov_b32_dpp v81, v19 row_shr:4 row_mask:0xf bank_mask:0x2
    v_mov_b32_dpp v82, v19 row_shr:8 row_mask:0xf bank_mask:0x4
    v_mov_b32_dpp v83, v19 row_shr:12 row_mask:0xf bank_mask:0x8
    v_mfma_f32_16x16x32_bf16 v[44:47], v[84:87], a[140:143], v[44:47]
    s_nop 0
    v_mfma_f32_16x16x32_bf16 v[44:47], v[80:83], a[144:147], v[44:47]
    s_mov_b32 s76, 2654435761
    v_mul_lo_u32 v22, v23, s76
    v_add_u32 v22, 2135587861, v22
    s_nop 4
    ds_write_b64 v8, v[44:45] offset:0
    s_lshl_b32 s76, s83, 10
    s_add_u32 s76, s76, 802816
    s_cmp_eq_u32 s72, 0
    s_cselect_b32 s79, s76, 1073741824
    s_waitcnt lgkmcnt(0)
    s_barrier
    ds_read2_b64 v[96:99], v13 offset0:0 offset1:64
    ds_read2_b64 v[100:103], v13 offset0:128 offset1:192
    v_mov_b32 v105, v22
    v_mov_b32 v107, v22
    s_waitcnt lgkmcnt(0)
    v_pk_add_f32 v[96:97], v[96:97], v[98:99]
    s_add_u32 s75, s75, 0x1000
    buffer_load_dwordx4 v[200:203], v4, s[28:31], s75 offen nt
    v_pk_add_f32 v[100:101], v[100:101], v[102:103]
    v_add_f32 v104, v96, v100
    v_add_f32 v106, v97, v101
    buffer_store_dwordx4 v[104:107], v4, s[52:55], s79 offen sc1
    v_mov_b32_dpp v80, v18 quad_perm:[0,1,2,3] row_mask:0xf bank_mask:0x1
    v_mov_b32_dpp v81, v18 row_shr:4 row_mask:0xf bank_mask:0x2
    v_mov_b32_dpp v82, v18 row_shr:8 row_mask:0xf bank_mask:0x4
    v_mov_b32_dpp v83, v18 row_shr:12 row_mask:0xf bank_mask:0x8
    s_waitcnt vmcnt(16)
    v_mov_b32_dpp v84, v18 row_shl:4 row_mask:0xf bank_mask:0x1
    v_mov_b32_dpp v85, v18 quad_perm:[0,1,2,3] row_mask:0xf bank_mask:0x2
    v_mov_b32_dpp v86, v18 row_shr:4 row_mask:0xf bank_mask:0x4
    v_mov_b32_dpp v87, v18 row_shr:8 row_mask:0xf bank_mask:0x8
    v_mfma_f32_16x16x32_bf16 v[88:91], v[80:83], a[148:151], 0
    v_mov_b32_dpp v80, v18 row_shl:8 row_mask:0xf bank_mask:0x1
    s_add_u32 s75, s75, 0x1000
    buffer_load_dwordx4 v[204:207], v4, s[28:31], s75 offen nt
    v_mov_b32_dpp v81, v18 row_shl:4 row_mask:0xf bank_mask:0x2
    v_mov_b32_dpp v82, v18 quad_perm:[0,1,2,3] row_mask:0xf bank_mask:0x4
    v_mov_b32_dpp v83, v18 row_shr:4 row_mask:0xf bank_mask:0x8
    v_mfma_f32_16x16x32_bf16 v[88:91], v[84:87], a[152:155], v[88:91]
    v_mov_b32_dpp v84, v18 row_shl:12 row_mask:0xf bank_mask:0x1
    v_mov_b32_dpp v85, v18 row_shl:8 row_mask:0xf bank_mask:0x2
    v_mov_b32_dpp v86, v18 row_shl:4 row_mask:0xf bank_mask:0x4
    v_mov_b32_dpp v87, v18 quad_perm:[0,1,2,3] row_mask:0xf bank_mask:0x8
    v_mfma_f32_16x16x32_bf16 v[88:91], v[80:83], a[156:159], v[88:91]
    v_mov_b32_dpp v80, v19 quad_perm:[0,1,2,3] row_mask:0xf bank_mask:0x1
    s_add_u32 s75, s75, 0x1000
    buffer_load_dwordx4 v[208:211], v4, s[28:31], s75 offen nt
    v_mov_b32_dpp v81, v19 row_shr:4 row_mask:0xf bank_mask:0x2
    v_mov_b32_dpp v82, v19 row_shr:8 row_mask:0xf bank_mask:0x4
    v_mov_b32_dpp v83, v19 row_shr:12 row_mask:0xf bank_mask:0x8
    v_mfma_f32_16x16x32_bf16 v[88:91], v[84:87], a[160:163], v[88:91]
    s_nop 0
    v_mfma_f32_16x16x32_bf16 v[88:91], v[80:83], a[164:167], v[88:91]
    s_nop 7
    ds_write_b64 v8, v[88:89] offset:4096
    s_mov_b32 s48, s20
    s_mov_b32 s49, s21
    s_mov_b32 s50, 2211840
    s_mov_b32 s51, 0x20000
    s_mov_b32 s56, s22
    s_mov_b32 s57, s23
    s_mov_b32 s58, 1280
    s_mov_b32 s59, 0x20000
    s_mov_b32 s40, s12
    s_mov_b32 s41, s13
    s_mov_b32 s42, 5242880
    s_mov_b32 s43, 0x20000
    s_mov_b32 s85, 0x3fb8aa3b
    s_add_u32 s75, s75, 0x1000
    buffer_load_dwordx4 v[212:215], v4, s[28:31], s75 offen nt
    s_add_u32 s75, s75, 0x1000
    buffer_load_dwordx4 v[216:219], v4, s[28:31], s75 offen nt
    s_add_u32 s75, s75, 0x1000
    buffer_load_dwordx4 v[220:223], v4, s[28:31], s75 offen nt
    s_add_u32 s75, s75, 0x1000
    buffer_load_dwordx4 v[224:227], v4, s[28:31], s75 offen nt
    s_add_u32 s75, s75, 0x1000
    buffer_load_dwordx4 v[228:231], v4, s[28:31], s75 offen nt
    s_add_u32 s75, s75, 0x1000
    buffer_load_dwordx4 v[232:235], v4, s[28:31], s75 offen nt
    s_add_u32 s75, s75, 0x1000
    buffer_load_dwordx4 v[236:239], v4, s[28:31], s75 offen nt
    s_add_u32 s75, s75, 0x1000
    buffer_load_dwordx4 v[240:243], v4, s[28:31], s75 offen nt
    s_add_u32 s75, s75, 0x1000
    buffer_load_dwordx4 v[244:247], v4, s[28:31], s75 offen nt
    s_add_u32 s75, s75, 0x1000
    buffer_load_dwordx4 v[248:251], v4, s[28:31], s75 offen nt
    s_add_u32 s75, s75, 0x1000
    buffer_load_dwordx4 v[252:255], v4, s[28:31], s75 offen nt
    s_add_u32 s75, s75, 0x1000
    s_and_b32 s75, s75, 0x7ffff
    buffer_load_dwordx4 a[0:3], v4, s[28:31], s75 offen nt
    s_add_u32 s75, s75, 0x1000
    buffer_load_dwordx4 a[4:7], v4, s[28:31], s75 offen nt
    s_add_u32 s75, s75, 0x1000
    buffer_load_dwordx4 a[8:11], v4, s[28:31], s75 offen nt
    s_add_u32 s75, s75, 0x1000
    buffer_load_dwordx4 a[12:15], v4, s[28:31], s75 offen nt
    s_add_u32 s75, s75, 0x1000
    buffer_load_dwordx4 a[16:19], v4, s[28:31], s75 offen nt
    s_add_u32 s75, s75, 0x1000
    buffer_load_dwordx4 a[20:23], v4, s[28:31], s75 offen nt
    s_add_u32 s75, s75, 0x1000
    buffer_load_dwordx4 a[24:27], v4, s[28:31], s75 offen nt
    s_add_u32 s75, s75, 0x1000
    buffer_load_dwordx4 a[28:31], v4, s[28:31], s75 offen nt
    s_add_u32 s75, s75, 0x1000
    buffer_load_dwordx4 a[32:35], v4, s[28:31], s75 offen nt
    s_add_u32 s75, s75, 0x1000
    buffer_load_dwordx4 a[36:39], v4, s[28:31], s75 offen nt
    s_add_u32 s75, s75, 0x1000
    buffer_load_dwordx4 a[40:43], v4, s[28:31], s75 offen nt
    s_add_u32 s75, s75, 0x1000
    buffer_load_dwordx4 a[44:47], v4, s[28:31], s75 offen nt
    s_add_u32 s75, s75, 0x1000
    buffer_load_dwordx4 a[48:51], v4, s[28:31], s75 offen nt
    s_add_u32 s75, s75, 0x1000
    buffer_load_dwordx4 a[52:55], v4, s[28:31], s75 offen nt
    s_lshl_b32 s76, s73, 13
    s_lshl_b32 s77, s72, 10
    s_add_u32 s76, s76, s77
    s_add_u32 s79, s76, 802816
    buffer_load_dwordx4 v[108:111], v4, s[52:55], s79 offen sc1
    buffer_load_dwordx4 v[112:115], v4, s[52:55], s79 offen offset:1024 sc1
    s_add_u32 s75, s75, 0x1000
    buffer_load_dwordx4 a[56:59], v4, s[28:31], s75 offen nt
    s_add_u32 s75, s75, 0x1000
    buffer_load_dwordx4 a[60:63], v4, s[28:31], s75 offen nt
    s_add_u32 s75, s75, 0x1000
    buffer_load_dwordx4 a[64:67], v4, s[28:31], s75 offen nt
    s_add_u32 s75, s75, 0x1000
    buffer_load_dwordx4 a[68:71], v4, s[28:31], s75 offen nt
    s_add_u32 s75, s75, 0x1000
    buffer_load_dwordx4 a[72:75], v4, s[28:31], s75 offen nt
    s_add_u32 s75, s75, 0x1000
    buffer_load_dwordx4 a[76:79], v4, s[28:31], s75 offen nt
    s_add_u32 s75, s75, 0x1000
    buffer_load_dwordx4 a[80:83], v4, s[28:31], s75 offen nt
    s_add_u32 s75, s75, 0x1000
    buffer_load_dwordx4 a[84:87], v4, s[28:31], s75 offen nt
    s_add_u32 s75, s75, 0x1000
    buffer_load_dwordx4 a[88:91], v4, s[28:31], s75 offen nt
    s_add_u32 s75, s75, 0x1000
    buffer_load_dwordx4 a[92:95], v4, s[28:31], s75 offen nt
    s_add_u32 s75, s75, 0x1000
    buffer_load_dwordx4 a[96:99], v4, s[28:31], s75 offen nt
    s_add_u32 s75, s75, 0x1000
    buffer_load_dwordx4 a[100:103], v4, s[28:31], s75 offen nt
    s_add_u32 s75, s75, 0x1000
    buffer_load_dwordx4 a[104:107], v4, s[28:31], s75 offen nt
    s_add_u32 s75, s75, 0x1000
    buffer_load_dwordx4 a[108:111], v4, s[28:31], s75 offen nt
    s_add_u32 s75, s75, 0x1000
    buffer_load_dwordx4 a[112:115], v4, s[28:31], s75 offen nt
    s_add_u32 s75, s75, 0x1000
    buffer_load_dwordx4 a[116:119], v4, s[28:31], s75 offen nt
    s_add_u32 s75, s75, 0x1000
    buffer_load_dwordx4 a[120:123], v4, s[28:31], s75 offen nt
    s_add_u32 s75, s75, 0x1000
    buffer_load_dwordx4 a[124:127], v4, s[28:31], s75 offen nt
    s_mov_b32 s86, 20000
    s_waitcnt vmcnt(18)
L_q:
    v_xor_b32 v26, v109, v22
    v_xor_b32 v27, v111, v22
    v_xor_b32 v113, v113, v22
    v_xor_b32 v115, v115, v22
    v_or3_b32 v26, v26, v27, v113
    v_or_b32 v26, v26, v115
    v_cmp_ne_u32 vcc, 0, v26
    s_nop 3
    s_cbranch_vccz L_q_done
    s_sub_u32 s86, s86, 1
    s_cbranch_scc1 L_q_done
    buffer_load_dwordx4 v[108:111], v4, s[52:55], s79 offen sc1
    buffer_load_dwordx4 v[112:115], v4, s[52:55], s79 offen offset:1024 sc1
    s_waitcnt vmcnt(0)
    s_branch L_q
L_q_done:
    v_add_f32 v26, v108, v112
    v_add_f32 v27, v110, v114
    ds_write_b64 v8, v[26:27] offset:6144
    v_lshlrev_b32 v28, 5, v3
    s_waitcnt lgkmcnt(0)
    s_barrier
    ds_read_b128 v[96:99], v28 offset:6144
    ds_read_b128 v[100:103], v28 offset:6160
    ds_read_b128 v[104:107], v28 offset:6656
    ds_read_b128 v[108:111], v28 offset:6672
    ds_read_b128 v[112:115], v28 offset:7168
    ds_read_b128 v[116:119], v28 offset:7184
    ds_read_b128 v[120:123], v28 offset:7680
    ds_read_b128 v[124:127], v28 offset:7696
    s_waitcnt lgkmcnt(4)
    v_pk_add_f32 v[96:97], v[96:97], v[104:105]
    v_pk_add_f32 v[98:99], v[98:99], v[106:107]
    v_pk_add_f32 v[100:101], v[100:101], v[108:109]
    v_pk_add_f32 v[102:103], v[102:103], v[110:111]
    s_waitcnt lgkmcnt(0)
    v_pk_add_f32 v[112:113], v[112:113], v[120:121]
    v_pk_add_f32 v[114:115], v[114:115], v[122:123]
    v_pk_add_f32 v[116:117], v[116:117], v[124:125]
    v_pk_add_f32 v[118:119], v[118:119], v[126:127]
    v_pk_add_f32 v[96:97], v[96:97], v[112:113]
    v_pk_add_f32 v[98:99], v[98:99], v[114:115]
    v_pk_add_f32 v[100:101], v[100:101], v[116:117]
    v_pk_add_f32 v[102:103], v[102:103], v[118:119]
    v_cvt_pk_bf16_f32 v92, v96, v97
    v_cvt_pk_bf16_f32 v93, v98, v99
    v_cvt_pk_bf16_f32 v94, v100, v101
    v_cvt_pk_bf16_f32 v95, v102, v103
    v_mov_b32 v14, 0xff800000
    s_waitcnt vmcnt(63)
    v_dot2_f32_bf16 v48, v128, v92, 0
    v_dot2_f32_bf16 v49, v132, v92, 0
    v_dot2_f32_bf16 v50, v136, v92, 0
    v_dot2_f32_bf16 v51, v140, v92, 0
    v_dot2c_f32_bf16 v48, v129, v93
    v_dot2c_f32_bf16 v49, v133, v93
    v_dot2c_f32_bf16 v50, v137, v93
    v_dot2c_f32_bf16 v51, v141, v93
    v_dot2c_f32_bf16 v48, v130, v94
    v_dot2c_f32_bf16 v49, v134, v94
    v_dot2c_f32_bf16 v50, v138, v94
    v_dot2c_f32_bf16 v51, v142, v94
    v_dot2c_f32_bf16 v48, v131, v95
    v_dot2c_f32_bf16 v49, v135, v95
    v_dot2c_f32_bf16 v50, v139, v95
    v_dot2c_f32_bf16 v51, v143, v95
    s_add_u32 s75, s75, 0x1000
    s_and_b32 s75, s75, 0x7ffff
    buffer_load_dwordx4 v[128:131], v4, s[28:31], s75 offen nt
    v_add_f32_dpp v48, v48, v48 row_ror:8 row_mask:0xf bank_mask:0x3
    v_add_f32_dpp v49, v49, v49 row_ror:8 row_mask:0xf bank_mask:0x3
    s_nop 0
    v_add_f32_dpp v48, v50, v50 row_ror:8 row_mask:0xf bank_mask:0xc
    v_add_f32_dpp v49, v51, v51 row_ror:8 row_mask:0xf bank_mask:0xc
    s_nop 0
    v_add_f32_dpp v96, v48, v48 row_shl:4 row_mask:0xf bank_mask:0x5
    s_nop 1
    v_add_f32_dpp v96, v49, v49 row_shr:4 row_mask:0xf bank_mask:0xa
    s_nop 1
    v_add_f32_dpp v96, v96, v96 quad_perm:[1,0,3,2] row_mask:0xf bank_mask:0xf
    s_nop 1
    v_add_f32_dpp v96, v96, v96 quad_perm:[2,3,0,1] row_mask:0xf bank_mask:0xf
    v_add_u32 v26, 4096, v13
    ds_read2_b64 v[30:33], v26 offset0:0 offset1:64
    ds_read2_b64 v[34:37], v26 offset0:128 offset1:192
    v_and_b32 v26, 7, v0
    v_bfe_u32 v27, v0, 3, 1
    v_lshl_add_u32 v27, v27, 2, v2
    v_lshlrev_b32 v27, 4, v27
    v_lshl_add_u32 v21, v26, 10, v27
    v_lshl_add_u32 v26, v26, 7, v27
    v_mov_b32 v39, v22
    v_mov_b32 v41, v22
    s_lshl_b32 s76, s81, 10
    s_add_u32 s76, s76, 1069056
    s_cmp_eq_u32 s72, 1
    s_cselect_b32 s76, s76, 1073741824
    s_waitcnt lgkmcnt(0)
    v_pk_add_f32 v[30:31], v[30:31], v[32:33]
    v_pk_add_f32 v[34:35], v[34:35], v[36:37]
    v_add_f32 v38, v30, v34
    v_add_f32 v40, v31, v35
    buffer_store_dwordx4 v[38:41], v26, s[52:55], s76 offen sc1
    s_lshl_b32 s76, s80, 13
    s_lshl_b32 s77, s87, 7
    s_add_u32 s76, s76, s77
    s_add_u32 s76, s76, 1069056
    s_cmp_lt_u32 s72, 2
    s_cselect_b32 s76, s76, 1073741824
    v_add_u32 v21, s76, v21
    s_waitcnt vmcnt(61)
    v_dot2_f32_bf16 v48, v144, v92, 0
    v_dot2_f32_bf16 v49, v148, v92, 0
    v_dot2_f32_bf16 v50, v152, v92, 0
    v_dot2_f32_bf16 v51, v156, v92, 0
    v_dot2c_f32_bf16 v48, v145, v93
    v_dot2c_f32_bf16 v49, v149, v93
    v_dot2c_f32_bf16 v50, v153, v93
    v_dot2c_f32_bf16 v51, v157, v93
    v_dot2c_f32_bf16 v48, v146, v94
    v_dot2c_f32_bf16 v49, v150, v94
    v_dot2c_f32_bf16 v50, v154, v94
    v_dot2c_f32_bf16 v51, v158, v94
    v_dot2c_f32_bf16 v48, v147, v95
    v_dot2c_f32_bf16 v49, v151, v95
    v_dot2c_f32_bf16 v50, v155, v95
    v_dot2c_f32_bf16 v51, v159, v95
    s_add_u32 s75, s75, 0x1000
    buffer_load_dwordx4 v[132:135], v4, s[28:31], s75 offen nt
    v_add_f32_dpp v48, v48, v48 row_ror:8 row_mask:0xf bank_mask:0x3
    v_add_f32_dpp v49, v49, v49 row_ror:8 row_mask:0xf bank_mask:0x3
    s_nop 0
    v_add_f32_dpp v48, v50, v50 row_ror:8 row_mask:0xf bank_mask:0xc
    v_add_f32_dpp v49, v51, v51 row_ror:8 row_mask:0xf bank_mask:0xc
    s_nop 0
    v_add_f32_dpp v97, v48, v48 row_shl:4 row_mask:0xf bank_mask:0x5
    s_nop 1
    v_add_f32_dpp v97, v49, v49 row_shr:4 row_mask:0xf bank_mask:0xa
    s_nop 1
    v_add_f32_dpp v97, v97, v97 quad_perm:[1,0,3,2] row_mask:0xf bank_mask:0xf
    s_nop 1
    v_add_f32_dpp v97, v97, v97 quad_perm:[2,3,0,1] row_mask:0xf bank_mask:0xf
    v_cvt_pk_bf16_f32 v48, v96, v97
    v_lshlrev_b32 v96, 16, v48
    v_and_b32 v97, 0xffff0000, v48
    v_mul_f32 v96, 0x3db504f3, v96
    v_mul_f32 v97, 0x3db504f3, v97
    v_cvt_pk_bf16_f32 v48, v96, v97
    v_lshlrev_b32 v96, 16, v48
    v_and_b32 v97, 0xffff0000, v48
    v_max3_f32 v14, v96, v97, v14
    s_mul_i32 s76, s72, 2560
    v_lshl_add_u32 v5, v1, 3, s76
    v_lshlrev_b32 v8, 3, v0
    s_mul_i32 s76, s72, 640
    v_lshl_add_u32 v13, v1, 4, s76
    s_mul_i32 s76, s2, 2560
    v_add_u32 v26, s76, v13
    v_cmp_gt_u32 vcc, 40, v1
    s_nop 1
    v_cndmask_b32 v6, v24, v26, vcc
    s_lshl_b32 s76, s72, 7
    v_lshl_add_u32 v11, v2, 4, s76
    s_lshl2_add_u32 s76, s83, s72
    s_lshl_b32 s76, s76, 4
    s_add_u32 s76, s76, 655360
    v_lshl_add_u32 v26, v1, 4, s76
    v_cmp_gt_u32 vcc, 1, v1
    s_nop 1
    v_cndmask_b32 v7, v24, v26, vcc
    v_lshrrev_b32 v26, 2, v1
    v_mul_u32_u24 v26, 2560, v26
    v_and_b32 v27, 3, v0
    v_lshl_add_u32 v26, v27, 4, v26
    s_mul_i32 s76, s72, 163840
    s_sub_u32 s77, s81, 216
    s_lshl_b32 s77, s77, 6
    s_add_u32 s76, s76, s77
    v_add_u32 v12, s76, v26
    s_mov_b32 s60, 117835008
    s_mov_b32 s61, 117835009
    s_mov_b32 s62, 117835010
    s_mov_b32 s63, 117835011
    s_mov_b32 s3, 0x0c0c0400
    v_mov_b32 v52, 0x0c0c0c0c
    v_mov_b32 v53, 0x0c0c0c0c
    v_mov_b32 v54, 0x0c0c0c0c
    v_mov_b32 v55, 0x0c0c0c0c
    v_mov_b32_dpp v52, v10 quad_perm:[0,1,2,3] row_mask:0xf bank_mask:0x1
    v_mov_b32_dpp v53, v10 quad_perm:[0,1,2,3] row_mask:0xf bank_mask:0x2
    v_mov_b32_dpp v54, v10 quad_perm:[0,1,2,3] row_mask:0xf bank_mask:0x4
    v_mov_b32_dpp v55, v10 quad_perm:[0,1,2,3] row_mask:0xf bank_mask:0x8
    s_waitcnt vmcnt(58)
    v_dot2_f32_bf16 v48, v160, v92, 0
    v_dot2_f32_bf16 v49, v164, v92, 0
    v_dot2_f32_bf16 v50, v168, v92, 0
    v_dot2_f32_bf16 v51, v172, v92, 0
    v_dot2c_f32_bf16 v48, v161, v93
    v_dot2c_f32_bf16 v49, v165, v93
    v_dot2c_f32_bf16 v50, v169, v93
    v_dot2c_f32_bf16 v51, v173, v93
    v_dot2c_f32_bf16 v48, v162, v94
    v_dot2c_f32_bf16 v49, v166, v94
    v_dot2c_f32_bf16 v50, v170, v94
    v_dot2c_f32_bf16 v51, v174, v94
    v_dot2c_f32_bf16 v48, v163, v95
    v_dot2c_f32_bf16 v49, v167, v95
    v_dot2c_f32_bf16 v50, v171, v95
    v_dot2c_f32_bf16 v51, v175, v95
    v_add_f32_dpp v48, v48, v48 row_ror:8 row_mask:0xf bank_mask:0x3
    v_add_f32_dpp v49, v49, v49 row_ror:8 row_mask:0xf bank_mask:0x3
    s_nop 0
    v_add_f32_dpp v48, v50, v50 row_ror:8 row_mask:0xf bank_mask:0xc
    v_add_f32_dpp v49, v51, v51 row_ror:8 row_mask:0xf bank_mask:0xc
    s_nop 0
    v_add_f32_dpp v98, v48, v48 row_shl:4 row_mask:0xf bank_mask:0x5
    s_nop 1
    v_add_f32_dpp v98, v49, v49 row_shr:4 row_mask:0xf bank_mask:0xa
    s_nop 1
    v_add_f32_dpp v98, v98, v98 quad_perm:[1,0,3,2] row_mask:0xf bank_mask:0xf
    s_nop 1
    v_add_f32_dpp v98, v98, v98 quad_perm:[2,3,0,1] row_mask:0xf bank_mask:0xf
    s_waitcnt vmcnt(54)
    v_dot2_f32_bf16 v48, v176, v92, 0
    v_dot2_f32_bf16 v49, v180, v92, 0
    v_dot2_f32_bf16 v50, v184, v92, 0
    v_dot2_f32_bf16 v51, v188, v92, 0
    v_dot2c_f32_bf16 v48, v177, v93
    v_dot2c_f32_bf16 v49, v181, v93
    v_dot2c_f32_bf16 v50, v185, v93
    v_dot2c_f32_bf16 v51, v189, v93
    v_dot2c_f32_bf16 v48, v178, v94
    v_dot2c_f32_bf16 v49, v182, v94
    v_dot2c_f32_bf16 v50, v186, v94
    v_dot2c_f32_bf16 v51, v190, v94
    v_dot2c_f32_bf16 v48, v179, v95
    v_dot2c_f32_bf16 v49, v183, v95
    v_dot2c_f32_bf16 v50, v187, v95
    v_dot2c_f32_bf16 v51, v191, v95
    s_add_u32 s75, s75, 0x1000
    buffer_load_dwordx4 v[136:139], v4, s[28:31], s75 offen nt
    v_add_f32_dpp v48, v48, v48 row_ror:8 row_mask:0xf bank_mask:0x3
    v_add_f32_dpp v49, v49, v49 row_ror:8 row_mask:0xf bank_mask:0x3
    s_nop 0
    v_add_f32_dpp v48, v50, v50 row_ror:8 row_mask:0xf bank_mask:0xc
    v_add_f32_dpp v49, v51, v51 row_ror:8 row_mask:0xf bank_mask:0xc
    s_nop 0
    v_add_f32_dpp v99, v48, v48 row_shl:4 row_mask:0xf bank_mask:0x5
    s_nop 1
    v_add_f32_dpp v99, v49, v49 row_shr:4 row_mask:0xf bank_mask:0xa
    s_nop 1
    v_add_f32_dpp v99, v99, v99 quad_perm:[1,0,3,2] row_mask:0xf bank_mask:0xf
    s_nop 1
    v_add_f32_dpp v99, v99, v99 quad_perm:[2,3,0,1] row_mask:0xf bank_mask:0xf
    v_cvt_pk_bf16_f32 v48, v98, v99
    v_lshlrev_b32 v98, 16, v48
    v_and_b32 v99, 0xffff0000, v48
    v_mul_f32 v98, 0x3db504f3, v98
    v_mul_f32 v99, 0x3db504f3, v99
    v_cvt_pk_bf16_f32 v48, v98, v99
    v_lshlrev_b32 v98, 16, v48
    v_and_b32 v99, 0xffff0000, v48
    v_max3_f32 v14, v98, v99, v14
    s_waitcnt vmcnt(50)
    v_dot2_f32_bf16 v48, v192, v92, 0
    v_dot2_f32_bf16 v49, v196, v92, 0
    v_dot2_f32_bf16 v50, v200, v92, 0
    v_dot2_f32_bf16 v51, v204, v92, 0
    v_dot2c_f32_bf16 v48, v193, v93
    v_dot2c_f32_bf16 v49, v197, v93
    v_dot2c_f32_bf16 v50, v201, v93
    v_dot2c_f32_bf16 v51, v205, v93
    v_dot2c_f32_bf16 v48, v194, v94
    v_dot2c_f32_bf16 v49, v198, v94
    v_dot2c_f32_bf16 v50, v202, v94
    v_dot2c_f32_bf16 v51, v206, v94
    v_dot2c_f32_bf16 v48, v195, v95
    v_dot2c_f32_bf16 v49, v199, v95
    v_dot2c_f32_bf16 v50, v203, v95
    v_dot2c_f32_bf16 v51, v207, v95
    v_add_f32_dpp v48, v48, v48 row_ror:8 row_mask:0xf bank_mask:0x3
    v_add_f32_dpp v49, v49, v49 row_ror:8 row_mask:0xf bank_mask:0x3
    s_nop 0
    v_add_f32_dpp v48, v50, v50 row_ror:8 row_mask:0xf bank_mask:0xc
    v_add_f32_dpp v49, v51, v51 row_ror:8 row_mask:0xf bank_mask:0xc
    s_nop 0
    v_add_f32_dpp v100, v48, v48 row_shl:4 row_mask:0xf bank_mask:0x5
    s_nop 1
    v_add_f32_dpp v100, v49, v49 row_shr:4 row_mask:0xf bank_mask:0xa
    s_nop 1
    v_add_f32_dpp v100, v100, v100 quad_perm:[1,0,3,2] row_mask:0xf bank_mask:0xf
    s_nop 1
    v_add_f32_dpp v100, v100, v100 quad_perm:[2,3,0,1] row_mask:0xf bank_mask:0xf
    s_waitcnt vmcnt(46)
    v_dot2_f32_bf16 v48, v208, v92, 0
    v_dot2_f32_bf16 v49, v212, v92, 0
    v_dot2_f32_bf16 v50, v216, v92, 0
    v_dot2_f32_bf16 v51, v220, v92, 0
    v_dot2c_f32_bf16 v48, v209, v93
    v_dot2c_f32_bf16 v49, v213, v93
    v_dot2c_f32_bf16 v50, v217, v93
    v_dot2c_f32_bf16 v51, v221, v93
    v_dot2c_f32_bf16 v48, v210, v94
    v_dot2c_f32_bf16 v49, v214, v94
    v_dot2c_f32_bf16 v50, v218, v94
    v_dot2c_f32_bf16 v51, v222, v94
    v_dot2c_f32_bf16 v48, v211, v95
    v_dot2c_f32_bf16 v49, v215, v95
    v_dot2c_f32_bf16 v50, v219, v95
    v_dot2c_f32_bf16 v51, v223, v95
    s_add_u32 s75, s75, 0x1000
    buffer_load_dwordx4 v[140:143], v4, s[28:31], s75 offen nt
    v_add_f32_dpp v48, v48, v48 row_ror:8 row_mask:0xf bank_mask:0x3
    v_add_f32_dpp v49, v49, v49 row_ror:8 row_mask:0xf bank_mask:0x3
    s_nop 0
    v_add_f32_dpp v48, v50, v50 row_ror:8 row_mask:0xf bank_mask:0xc
    v_add_f32_dpp v49, v51, v51 row_ror:8 row_mask:0xf bank_mask:0xc
    s_nop 0
    v_add_f32_dpp v101, v48, v48 row_shl:4 row_mask:0xf bank_mask:0x5
    s_nop 1
    v_add_f32_dpp v101, v49, v49 row_shr:4 row_mask:0xf bank_mask:0xa
    s_nop 1
    v_add_f32_dpp v101, v101, v101 quad_perm:[1,0,3,2] row_mask:0xf bank_mask:0xf
    s_nop 1
    v_add_f32_dpp v101, v101, v101 quad_perm:[2,3,0,1] row_mask:0xf bank_mask:0xf
    v_cvt_pk_bf16_f32 v48, v100, v101
    v_lshlrev_b32 v100, 16, v48
    v_and_b32 v101, 0xffff0000, v48
    v_mul_f32 v100, 0x3db504f3, v100
    v_mul_f32 v101, 0x3db504f3, v101
    v_cvt_pk_bf16_f32 v48, v100, v101
    v_lshlrev_b32 v100, 16, v48
    v_and_b32 v101, 0xffff0000, v48
    v_max3_f32 v14, v100, v101, v14
    s_waitcnt vmcnt(43)
    v_dot2_f32_bf16 v48, v224, v92, 0
    v_dot2_f32_bf16 v49, v228, v92, 0
    v_dot2_f32_bf16 v50, v232, v92, 0
    v_dot2_f32_bf16 v51, v236, v92, 0
    v_dot2c_f32_bf16 v48, v225, v93
    v_dot2c_f32_bf16 v49, v229, v93
    v_dot2c_f32_bf16 v50, v233, v93
    v_dot2c_f32_bf16 v51, v237, v93
    v_dot2c_f32_bf16 v48, v226, v94
    v_dot2c_f32_bf16 v49, v230, v94
    v_dot2c_f32_bf16 v50, v234, v94
    v_dot2c_f32_bf16 v51, v238, v94
    v_dot2c_f32_bf16 v48, v227, v95
    v_dot2c_f32_bf16 v49, v231, v95
    v_dot2c_f32_bf16 v50, v235, v95
    v_dot2c_f32_bf16 v51, v239, v95
    v_add_f32_dpp v48, v48, v48 row_ror:8 row_mask:0xf bank_mask:0x3
    v_add_f32_dpp v49, v49, v49 row_ror:8 row_mask:0xf bank_mask:0x3
    s_nop 0
    v_add_f32_dpp v48, v50, v50 row_ror:8 row_mask:0xf bank_mask:0xc
    v_add_f32_dpp v49, v51, v51 row_ror:8 row_mask:0xf bank_mask:0xc
    s_nop 0
    v_add_f32_dpp v102, v48, v48 row_shl:4 row_mask:0xf bank_mask:0x5
    s_nop 1
    v_add_f32_dpp v102, v49, v49 row_shr:4 row_mask:0xf bank_mask:0xa
    s_nop 1
    v_add_f32_dpp v102, v102, v102 quad_perm:[1,0,3,2] row_mask:0xf bank_mask:0xf
    s_nop 1
    v_add_f32_dpp v102, v102, v102 quad_perm:[2,3,0,1] row_mask:0xf bank_mask:0xf
    s_waitcnt vmcnt(39)
    v_dot2_f32_bf16 v48, v240, v92, 0
    v_dot2_f32_bf16 v49, v244, v92, 0
    v_dot2_f32_bf16 v50, v248, v92, 0
    v_dot2_f32_bf16 v51, v252, v92, 0
    v_dot2c_f32_bf16 v48, v241, v93
    v_dot2c_f32_bf16 v49, v245, v93
    v_dot2c_f32_bf16 v50, v249, v93
    v_dot2c_f32_bf16 v51, v253, v93
    v_dot2c_f32_bf16 v48, v242, v94
    v_dot2c_f32_bf16 v49, v246, v94
    v_dot2c_f32_bf16 v50, v250, v94
    v_dot2c_f32_bf16 v51, v254, v94
    v_dot2c_f32_bf16 v48, v243, v95
    v_dot2c_f32_bf16 v49, v247, v95
    v_dot2c_f32_bf16 v50, v251, v95
    v_dot2c_f32_bf16 v51, v255, v95
    s_add_u32 s75, s75, 0x1000
    buffer_load_dwordx4 v[144:147], v4, s[28:31], s75 offen nt
    v_add_f32_dpp v48, v48, v48 row_ror:8 row_mask:0xf bank_mask:0x3
    v_add_f32_dpp v49, v49, v49 row_ror:8 row_mask:0xf bank_mask:0x3
    s_nop 0
    v_add_f32_dpp v48, v50, v50 row_ror:8 row_mask:0xf bank_mask:0xc
    v_add_f32_dpp v49, v51, v51 row_ror:8 row_mask:0xf bank_mask:0xc
    s_nop 0
    v_add_f32_dpp v103, v48, v48 row_shl:4 row_mask:0xf bank_mask:0x5
    s_nop 1
    v_add_f32_dpp v103, v49, v49 row_shr:4 row_mask:0xf bank_mask:0xa
    s_nop 1
    v_add_f32_dpp v103, v103, v103 quad_perm:[1,0,3,2] row_mask:0xf bank_mask:0xf
    s_nop 1
    v_add_f32_dpp v103, v103, v103 quad_perm:[2,3,0,1] row_mask:0xf bank_mask:0xf
    v_cvt_pk_bf16_f32 v48, v102, v103
    v_lshlrev_b32 v102, 16, v48
    v_and_b32 v103, 0xffff0000, v48
    v_mul_f32 v102, 0x3db504f3, v102
    v_mul_f32 v103, 0x3db504f3, v103
    v_cvt_pk_bf16_f32 v48, v102, v103
    v_lshlrev_b32 v102, 16, v48
    v_and_b32 v103, 0xffff0000, v48
    v_max3_f32 v14, v102, v103, v14
    s_waitcnt vmcnt(36)
    v_accvgpr_read_b32 v64, a0
    v_accvgpr_read_b32 v68, a4
    v_accvgpr_read_b32 v72, a8
    v_accvgpr_read_b32 v76, a12
    v_accvgpr_read_b32 v65, a1
    v_accvgpr_read_b32 v69, a5
    v_accvgpr_read_b32 v73, a9
    v_accvgpr_read_b32 v77, a13
    v_accvgpr_read_b32 v66, a2
    v_accvgpr_read_b32 v70, a6
    v_accvgpr_read_b32 v74, a10
    v_accvgpr_read_b32 v78, a14
    v_accvgpr_read_b32 v67, a3
    v_accvgpr_read_b32 v71, a7
    v_accvgpr_read_b32 v75, a11
    v_accvgpr_read_b32 v79, a15
    v_dot2_f32_bf16 v48, v64, v92, 0
    v_dot2_f32_bf16 v49, v68, v92, 0
    v_dot2_f32_bf16 v50, v72, v92, 0
    v_dot2_f32_bf16 v51, v76, v92, 0
    v_dot2c_f32_bf16 v48, v65, v93
    v_dot2c_f32_bf16 v49, v69, v93
    v_dot2c_f32_bf16 v50, v73, v93
    v_dot2c_f32_bf16 v51, v77, v93
    v_dot2c_f32_bf16 v48, v66, v94
    v_dot2c_f32_bf16 v49, v70, v94
    v_dot2c_f32_bf16 v50, v74, v94
    v_dot2c_f32_bf16 v51, v78, v94
    v_dot2c_f32_bf16 v48, v67, v95
    v_dot2c_f32_bf16 v49, v71, v95
    v_dot2c_f32_bf16 v50, v75, v95
    v_dot2c_f32_bf16 v51, v79, v95
    s_add_u32 s75, s75, 0x1000
    buffer_load_dwordx4 v[148:151], v4, s[28:31], s75 offen nt
    v_add_f32_dpp v48, v48, v48 row_ror:8 row_mask:0xf bank_mask:0x3
    v_add_f32_dpp v49, v49, v49 row_ror:8 row_mask:0xf bank_mask:0x3
    s_nop 0
    v_add_f32_dpp v48, v50, v50 row_ror:8 row_mask:0xf bank_mask:0xc
    v_add_f32_dpp v49, v51, v51 row_ror:8 row_mask:0xf bank_mask:0xc
    s_nop 0
    v_add_f32_dpp v104, v48, v48 row_shl:4 row_mask:0xf bank_mask:0x5
    s_nop 1
    v_add_f32_dpp v104, v49, v49 row_shr:4 row_mask:0xf bank_mask:0xa
    s_nop 1
    v_add_f32_dpp v104, v104, v104 quad_perm:[1,0,3,2] row_mask:0xf bank_mask:0xf
    s_nop 1
    v_add_f32_dpp v104, v104, v104 quad_perm:[2,3,0,1] row_mask:0xf bank_mask:0xf
    s_waitcnt vmcnt(33)
    v_accvgpr_read_b32 v64, a16
    v_accvgpr_read_b32 v68, a20
    v_accvgpr_read_b32 v72, a24
    v_accvgpr_read_b32 v76, a28
    v_accvgpr_read_b32 v65, a17
    v_accvgpr_read_b32 v69, a21
    v_accvgpr_read_b32 v73, a25
    v_accvgpr_read_b32 v77, a29
    v_accvgpr_read_b32 v66, a18
    v_accvgpr_read_b32 v70, a22
    v_accvgpr_read_b32 v74, a26
    v_accvgpr_read_b32 v78, a30
    v_accvgpr_read_b32 v67, a19
    v_accvgpr_read_b32 v71, a23
    v_accvgpr_read_b32 v75, a27
    v_accvgpr_read_b32 v79, a31
    v_dot2_f32_bf16 v48, v64, v92, 0
    v_dot2_f32_bf16 v49, v68, v92, 0
    v_dot2_f32_bf16 v50, v72, v92, 0
    v_dot2_f32_bf16 v51, v76, v92, 0
    v_dot2c_f32_bf16 v48, v65, v93
    v_dot2c_f32_bf16 v49, v69, v93
    v_dot2c_f32_bf16 v50, v73, v93
    v_dot2c_f32_bf16 v51, v77, v93
    v_dot2c_f32_bf16 v48, v66, v94
    v_dot2c_f32_bf16 v49, v70, v94
    v_dot2c_f32_bf16 v50, v74, v94
    v_dot2c_f32_bf16 v51, v78, v94
    v_dot2c_f32_bf16 v48, v67, v95
    v_dot2c_f32_bf16 v49, v71, v95
    v_dot2c_f32_bf16 v50, v75, v95
    v_dot2c_f32_bf16 v51, v79, v95
    v_add_f32_dpp v48, v48, v48 row_ror:8 row_mask:0xf bank_mask:0x3
    v_add_f32_dpp v49, v49, v49 row_ror:8 row_mask:0xf bank_mask:0x3
    s_nop 0
    v_add_f32_dpp v48, v50, v50 row_ror:8 row_mask:0xf bank_mask:0xc
    v_add_f32_dpp v49, v51, v51 row_ror:8 row_mask:0xf bank_mask:0xc
    s_nop 0
    v_add_f32_dpp v105, v48, v48 row_shl:4 row_mask:0xf bank_mask:0x5
    s_nop 1
    v_add_f32_dpp v105, v49, v49 row_shr:4 row_mask:0xf bank_mask:0xa
    s_nop 1
    v_add_f32_dpp v105, v105, v105 quad_perm:[1,0,3,2] row_mask:0xf bank_mask:0xf
    s_nop 1
    v_add_f32_dpp v105, v105, v105 quad_perm:[2,3,0,1] row_mask:0xf bank_mask:0xf
    v_cvt_pk_bf16_f32 v48, v104, v105
    v_lshlrev_b32 v104, 16, v48
    v_and_b32 v105, 0xffff0000, v48
    v_mul_f32 v104, 0x3db504f3, v104
    v_mul_f32 v105, 0x3db504f3, v105
    v_cvt_pk_bf16_f32 v48, v104, v105
    v_lshlrev_b32 v104, 16, v48
    v_and_b32 v105, 0xffff0000, v48
    v_max3_f32 v14, v104, v105, v14
    s_waitcnt vmcnt(29)
    v_accvgpr_read_b32 v64, a32
    v_accvgpr_read_b32 v68, a36
    v_accvgpr_read_b32 v72, a40
    v_accvgpr_read_b32 v76, a44
    v_accvgpr_read_b32 v65, a33
    v_accvgpr_read_b32 v69, a37
    v_accvgpr_read_b32 v73, a41
    v_accvgpr_read_b32 v77, a45
    v_accvgpr_read_b32 v66, a34
    v_accvgpr_read_b32 v70, a38
    v_accvgpr_read_b32 v74, a42
    v_accvgpr_read_b32 v78, a46
    v_accvgpr_read_b32 v67, a35
    v_accvgpr_read_b32 v71, a39
    v_accvgpr_read_b32 v75, a43
    v_accvgpr_read_b32 v79, a47
    v_dot2_f32_bf16 v48, v64, v92, 0
    v_dot2_f32_bf16 v49, v68, v92, 0
    v_dot2_f32_bf16 v50, v72, v92, 0
    v_dot2_f32_bf16 v51, v76, v92, 0
    v_dot2c_f32_bf16 v48, v65, v93
    v_dot2c_f32_bf16 v49, v69, v93
    v_dot2c_f32_bf16 v50, v73, v93
    v_dot2c_f32_bf16 v51, v77, v93
    v_dot2c_f32_bf16 v48, v66, v94
    v_dot2c_f32_bf16 v49, v70, v94
    v_dot2c_f32_bf16 v50, v74, v94
    v_dot2c_f32_bf16 v51, v78, v94
    v_dot2c_f32_bf16 v48, v67, v95
    v_dot2c_f32_bf16 v49, v71, v95
    v_dot2c_f32_bf16 v50, v75, v95
    v_dot2c_f32_bf16 v51, v79, v95
    s_add_u32 s75, s75, 0x1000
    buffer_load_dwordx4 v[152:155], v4, s[28:31], s75 offen nt
    v_add_f32_dpp v48, v48, v48 row_ror:8 row_mask:0xf bank_mask:0x3
    v_add_f32_dpp v49, v49, v49 row_ror:8 row_mask:0xf bank_mask:0x3
    s_nop 0
    v_add_f32_dpp v48, v50, v50 row_ror:8 row_mask:0xf bank_mask:0xc
    v_add_f32_dpp v49, v51, v51 row_ror:8 row_mask:0xf bank_mask:0xc
    s_nop 0
    v_add_f32_dpp v106, v48, v48 row_shl:4 row_mask:0xf bank_mask:0x5
    s_nop 1
    v_add_f32_dpp v106, v49, v49 row_shr:4 row_mask:0xf bank_mask:0xa
    s_nop 1
    v_add_f32_dpp v106, v106, v106 quad_perm:[1,0,3,2] row_mask:0xf bank_mask:0xf
    s_nop 1
    v_add_f32_dpp v106, v106, v106 quad_perm:[2,3,0,1] row_mask:0xf bank_mask:0xf
    s_waitcnt vmcnt(24)
    v_accvgpr_read_b32 v64, a48
    v_accvgpr_read_b32 v68, a52
    v_accvgpr_read_b32 v72, a56
    v_accvgpr_read_b32 v76, a60
    v_accvgpr_read_b32 v65, a49
    v_accvgpr_read_b32 v69, a53
    v_accvgpr_read_b32 v73, a57
    v_accvgpr_read_b32 v77, a61
    v_accvgpr_read_b32 v66, a50
    v_accvgpr_read_b32 v70, a54
    v_accvgpr_read_b32 v74, a58
    v_accvgpr_read_b32 v78, a62
    v_accvgpr_read_b32 v67, a51
    v_accvgpr_read_b32 v71, a55
    v_accvgpr_read_b32 v75, a59
    v_accvgpr_read_b32 v79, a63
    v_dot2_f32_bf16 v48, v64, v92, 0
    v_dot2_f32_bf16 v49, v68, v92, 0
    v_dot2_f32_bf16 v50, v72, v92, 0
    v_dot2_f32_bf16 v51, v76, v92, 0
    v_dot2c_f32_bf16 v48, v65, v93
    v_dot2c_f32_bf16 v49, v69, v93
    v_dot2c_f32_bf16 v50, v73, v93
    v_dot2c_f32_bf16 v51, v77, v93
    v_dot2c_f32_bf16 v48, v66, v94
    v_dot2c_f32_bf16 v49, v70, v94
    v_dot2c_f32_bf16 v50, v74, v94
    v_dot2c_f32_bf16 v51, v78, v94
    v_dot2c_f32_bf16 v48, v67, v95
    v_dot2c_f32_bf16 v49, v71, v95
    v_dot2c_f32_bf16 v50, v75, v95
    v_dot2c_f32_bf16 v51, v79, v95
    v_add_f32_dpp v48, v48, v48 row_ror:8 row_mask:0xf bank_mask:0x3
    v_add_f32_dpp v49, v49, v49 row_ror:8 row_mask:0xf bank_mask:0x3
    s_nop 0
    v_add_f32_dpp v48, v50, v50 row_ror:8 row_mask:0xf bank_mask:0xc
    v_add_f32_dpp v49, v51, v51 row_ror:8 row_mask:0xf bank_mask:0xc
    s_nop 0
    v_add_f32_dpp v107, v48, v48 row_shl:4 row_mask:0xf bank_mask:0x5
    s_nop 1
    v_add_f32_dpp v107, v49, v49 row_shr:4 row_mask:0xf bank_mask:0xa
    s_nop 1
    v_add_f32_dpp v107, v107, v107 quad_perm:[1,0,3,2] row_mask:0xf bank_mask:0xf
    s_nop 1
    v_add_f32_dpp v107, v107, v107 quad_perm:[2,3,0,1] row_mask:0xf bank_mask:0xf
    v_cvt_pk_bf16_f32 v48, v106, v107
    v_lshlrev_b32 v106, 16, v48
    v_and_b32 v107, 0xffff0000, v48
    v_mul_f32 v106, 0x3db504f3, v106
    v_mul_f32 v107, 0x3db504f3, v107
    v_cvt_pk_bf16_f32 v48, v106, v107
    v_lshlrev_b32 v106, 16, v48
    v_and_b32 v107, 0xffff0000, v48
    v_max3_f32 v14, v106, v107, v14
    s_waitcnt vmcnt(20)
    v_accvgpr_read_b32 v64, a64
    v_accvgpr_read_b32 v68, a68
    v_accvgpr_read_b32 v72, a72
    v_accvgpr_read_b32 v76, a76
    v_accvgpr_read_b32 v65, a65
    v_accvgpr_read_b32 v69, a69
    v_accvgpr_read_b32 v73, a73
    v_accvgpr_read_b32 v77, a77
    v_accvgpr_read_b32 v66, a66
    v_accvgpr_read_b32 v70, a70
    v_accvgpr_read_b32 v74, a74
    v_accvgpr_read_b32 v78, a78
    v_accvgpr_read_b32 v67, a67
    v_accvgpr_read_b32 v71, a71
    v_accvgpr_read_b32 v75, a75
    v_accvgpr_read_b32 v79, a79
    v_dot2_f32_bf16 v48, v64, v92, 0
    v_dot2_f32_bf16 v49, v68, v92, 0
    v_dot2_f32_bf16 v50, v72, v92, 0
    v_dot2_f32_bf16 v51, v76, v92, 0
    v_dot2c_f32_bf16 v48, v65, v93
    v_dot2c_f32_bf16 v49, v69, v93
    v_dot2c_f32_bf16 v50, v73, v93
    v_dot2c_f32_bf16 v51, v77, v93
    v_dot2c_f32_bf16 v48, v66, v94
    v_dot2c_f32_bf16 v49, v70, v94
    v_dot2c_f32_bf16 v50, v74, v94
    v_dot2c_f32_bf16 v51, v78, v94
    v_dot2c_f32_bf16 v48, v67, v95
    v_dot2c_f32_bf16 v49, v71, v95
    v_dot2c_f32_bf16 v50, v75, v95
    v_dot2c_f32_bf16 v51, v79, v95
    s_add_u32 s75, s75, 0x1000
    buffer_load_dwordx4 v[156:159], v4, s[28:31], s75 offen nt
    v_add_f32_dpp v48, v48, v48 row_ror:8 row_mask:0xf bank_mask:0x3
    v_add_f32_dpp v49, v49, v49 row_ror:8 row_mask:0xf bank_mask:0x3
    s_nop 0
    v_add_f32_dpp v48, v50, v50 row_ror:8 row_mask:0xf bank_mask:0xc
    v_add_f32_dpp v49, v51, v51 row_ror:8 row_mask:0xf bank_mask:0xc
    s_nop 0
    v_add_f32_dpp v108, v48, v48 row_shl:4 row_mask:0xf bank_mask:0x5
    s_nop 1
    v_add_f32_dpp v108, v49, v49 row_shr:4 row_mask:0xf bank_mask:0xa
    s_nop 1
    v_add_f32_dpp v108, v108, v108 quad_perm:[1,0,3,2] row_mask:0xf bank_mask:0xf
    s_nop 1
    v_add_f32_dpp v108, v108, v108 quad_perm:[2,3,0,1] row_mask:0xf bank_mask:0xf
    s_waitcnt vmcnt(17)
    v_accvgpr_read_b32 v64, a80
    v_accvgpr_read_b32 v68, a84
    v_accvgpr_read_b32 v72, a88
    v_accvgpr_read_b32 v76, a92
    v_accvgpr_read_b32 v65, a81
    v_accvgpr_read_b32 v69, a85
    v_accvgpr_read_b32 v73, a89
    v_accvgpr_read_b32 v77, a93
    v_accvgpr_read_b32 v66, a82
    v_accvgpr_read_b32 v70, a86
    v_accvgpr_read_b32 v74, a90
    v_accvgpr_read_b32 v78, a94
    v_accvgpr_read_b32 v67, a83
    v_accvgpr_read_b32 v71, a87
    v_accvgpr_read_b32 v75, a91
    v_accvgpr_read_b32 v79, a95
    v_dot2_f32_bf16 v48, v64, v92, 0
    v_dot2_f32_bf16 v49, v68, v92, 0
    v_dot2_f32_bf16 v50, v72, v92, 0
    v_dot2_f32_bf16 v51, v76, v92, 0
    v_dot2c_f32_bf16 v48, v65, v93
    v_dot2c_f32_bf16 v49, v69, v93
    v_dot2c_f32_bf16 v50, v73, v93
    v_dot2c_f32_bf16 v51, v77, v93
    v_dot2c_f32_bf16 v48, v66, v94
    v_dot2c_f32_bf16 v49, v70, v94
    v_dot2c_f32_bf16 v50, v74, v94
    v_dot2c_f32_bf16 v51, v78, v94
    v_dot2c_f32_bf16 v48, v67, v95
    v_dot2c_f32_bf16 v49, v71, v95
    v_dot2c_f32_bf16 v50, v75, v95
    v_dot2c_f32_bf16 v51, v79, v95
    v_add_f32_dpp v48, v48, v48 row_ror:8 row_mask:0xf bank_mask:0x3
    v_add_f32_dpp v49, v49, v49 row_ror:8 row_mask:0xf bank_mask:0x3
    s_nop 0
    v_add_f32_dpp v48, v50, v50 row_ror:8 row_mask:0xf bank_mask:0xc
    v_add_f32_dpp v49, v51, v51 row_ror:8 row_mask:0xf bank_mask:0xc
    s_nop 0
    v_add_f32_dpp v109, v48, v48 row_shl:4 row_mask:0xf bank_mask:0x5
    s_nop 1
    v_add_f32_dpp v109, v49, v49 row_shr:4 row_mask:0xf bank_mask:0xa
    s_nop 1
    v_add_f32_dpp v109, v109, v109 quad_perm:[1,0,3,2] row_mask:0xf bank_mask:0xf
    s_nop 1
    v_add_f32_dpp v109, v109, v109 quad_perm:[2,3,0,1] row_mask:0xf bank_mask:0xf
    v_cvt_pk_bf16_f32 v48, v108, v109
    v_lshlrev_b32 v108, 16, v48
    v_and_b32 v109, 0xffff0000, v48
    v_mul_f32 v108, 0x3db504f3, v108
    v_mul_f32 v109, 0x3db504f3, v109
    v_cvt_pk_bf16_f32 v48, v108, v109
    v_lshlrev_b32 v108, 16, v48
    v_and_b32 v109, 0xffff0000, v48
    v_max3_f32 v14, v108, v109, v14
    s_waitcnt vmcnt(13)
    v_accvgpr_read_b32 v64, a96
    v_accvgpr_read_b32 v68, a100
    v_accvgpr_read_b32 v72, a104
    v_accvgpr_read_b32 v76, a108
    v_accvgpr_read_b32 v65, a97
    v_accvgpr_read_b32 v69, a101
    v_accvgpr_read_b32 v73, a105
    v_accvgpr_read_b32 v77, a109
    v_accvgpr_read_b32 v66, a98
    v_accvgpr_read_b32 v70, a102
    v_accvgpr_read_b32 v74, a106
    v_accvgpr_read_b32 v78, a110
    v_accvgpr_read_b32 v67, a99
    v_accvgpr_read_b32 v71, a103
    v_accvgpr_read_b32 v75, a107
    v_accvgpr_read_b32 v79, a111
    v_dot2_f32_bf16 v48, v64, v92, 0
    v_dot2_f32_bf16 v49, v68, v92, 0
    v_dot2_f32_bf16 v50, v72, v92, 0
    v_dot2_f32_bf16 v51, v76, v92, 0
    v_dot2c_f32_bf16 v48, v65, v93
    v_dot2c_f32_bf16 v49, v69, v93
    v_dot2c_f32_bf16 v50, v73, v93
    v_dot2c_f32_bf16 v51, v77, v93
    v_dot2c_f32_bf16 v48, v66, v94
    v_dot2c_f32_bf16 v49, v70, v94
    v_dot2c_f32_bf16 v50, v74, v94
    v_dot2c_f32_bf16 v51, v78, v94
    v_dot2c_f32_bf16 v48, v67, v95
    v_dot2c_f32_bf16 v49, v71, v95
    v_dot2c_f32_bf16 v50, v75, v95
    v_dot2c_f32_bf16 v51, v79, v95
    s_add_u32 s75, s75, 0x1000
    buffer_load_dwordx4 v[160:163], v4, s[28:31], s75 offen nt
    v_add_f32_dpp v48, v48, v48 row_ror:8 row_mask:0xf bank_mask:0x3
    v_add_f32_dpp v49, v49, v49 row_ror:8 row_mask:0xf bank_mask:0x3
    s_nop 0
    v_add_f32_dpp v48, v50, v50 row_ror:8 row_mask:0xf bank_mask:0xc
    v_add_f32_dpp v49, v51, v51 row_ror:8 row_mask:0xf bank_mask:0xc
    s_nop 0
    v_add_f32_dpp v110, v48, v48 row_shl:4 row_mask:0xf bank_mask:0x5
    s_nop 1
    v_add_f32_dpp v110, v49, v49 row_shr:4 row_mask:0xf bank_mask:0xa
    s_nop 1
    v_add_f32_dpp v110, v110, v110 quad_perm:[1,0,3,2] row_mask:0xf bank_mask:0xf
    s_nop 1
    v_add_f32_dpp v110, v110, v110 quad_perm:[2,3,0,1] row_mask:0xf bank_mask:0xf
    s_waitcnt vmcnt(10)
    v_accvgpr_read_b32 v64, a112
    v_accvgpr_read_b32 v68, a116
    v_accvgpr_read_b32 v72, a120
    v_accvgpr_read_b32 v76, a124
    v_accvgpr_read_b32 v65, a113
    v_accvgpr_read_b32 v69, a117
    v_accvgpr_read_b32 v73, a121
    v_accvgpr_read_b32 v77, a125
    v_accvgpr_read_b32 v66, a114
    v_accvgpr_read_b32 v70, a118
    v_accvgpr_read_b32 v74, a122
    v_accvgpr_read_b32 v78, a126
    v_accvgpr_read_b32 v67, a115
    v_accvgpr_read_b32 v71, a119
    v_accvgpr_read_b32 v75, a123
    v_accvgpr_read_b32 v79, a127
    v_dot2_f32_bf16 v48, v64, v92, 0
    v_dot2_f32_bf16 v49, v68, v92, 0
    v_dot2_f32_bf16 v50, v72, v92, 0
    v_dot2_f32_bf16 v51, v76, v92, 0
    v_dot2c_f32_bf16 v48, v65, v93
    v_dot2c_f32_bf16 v49, v69, v93
    v_dot2c_f32_bf16 v50, v73, v93
    v_dot2c_f32_bf16 v51, v77, v93
    v_dot2c_f32_bf16 v48, v66, v94
    v_dot2c_f32_bf16 v49, v70, v94
    v_dot2c_f32_bf16 v50, v74, v94
    v_dot2c_f32_bf16 v51, v78, v94
    v_dot2c_f32_bf16 v48, v67, v95
    v_dot2c_f32_bf16 v49, v71, v95
    v_dot2c_f32_bf16 v50, v75, v95
    v_dot2c_f32_bf16 v51, v79, v95
    v_add_f32_dpp v48, v48, v48 row_ror:8 row_mask:0xf bank_mask:0x3
    v_add_f32_dpp v49, v49, v49 row_ror:8 row_mask:0xf bank_mask:0x3
    s_nop 0
    v_add_f32_dpp v48, v50, v50 row_ror:8 row_mask:0xf bank_mask:0xc
    v_add_f32_dpp v49, v51, v51 row_ror:8 row_mask:0xf bank_mask:0xc
    s_nop 0
    v_add_f32_dpp v111, v48, v48 row_shl:4 row_mask:0xf bank_mask:0x5
    s_nop 1
    v_add_f32_dpp v111, v49, v49 row_shr:4 row_mask:0xf bank_mask:0xa
    s_nop 1
    v_add_f32_dpp v111, v111, v111 quad_perm:[1,0,3,2] row_mask:0xf bank_mask:0xf
    s_nop 1
    v_add_f32_dpp v111, v111, v111 quad_perm:[2,3,0,1] row_mask:0xf bank_mask:0xf
    v_cvt_pk_bf16_f32 v48, v110, v111
    v_lshlrev_b32 v110, 16, v48
    v_and_b32 v111, 0xffff0000, v48
    v_mul_f32 v110, 0x3db504f3, v110
    v_mul_f32 v111, 0x3db504f3, v111
    v_cvt_pk_bf16_f32 v48, v110, v111
    v_lshlrev_b32 v110, 16, v48
    v_and_b32 v111, 0xffff0000, v48
    v_max3_f32 v14, v110, v111, v14
    s_waitcnt vmcnt(5)
    v_dot2_f32_bf16 v48, v128, v92, 0
    v_dot2_f32_bf16 v49, v132, v92, 0
    v_dot2_f32_bf16 v50, v136, v92, 0
    v_dot2_f32_bf16 v51, v140, v92, 0
    v_dot2c_f32_bf16 v48, v129, v93
    v_dot2c_f32_bf16 v49, v133, v93
    v_dot2c_f32_bf16 v50, v137, v93
    v_dot2c_f32_bf16 v51, v141, v93
    v_dot2c_f32_bf16 v48, v130, v94
    v_dot2c_f32_bf16 v49, v134, v94
    v_dot2c_f32_bf16 v50, v138, v94
    v_dot2c_f32_bf16 v51, v142, v94
    v_dot2c_f32_bf16 v48, v131, v95
    v_dot2c_f32_bf16 v49, v135, v95
    v_dot2c_f32_bf16 v50, v139, v95
    v_dot2c_f32_bf16 v51, v143, v95
    s_add_u32 s75, s75, 0x1000
    buffer_load_dwordx4 v[164:167], v4, s[28:31], s75 offen nt
    s_add_u32 s75, s75, 0x1000
    buffer_load_dwordx4 v[168:171], v4, s[28:31], s75 offen nt
    s_add_u32 s75, s75, 0x1000
    buffer_load_dwordx4 v[172:175], v4, s[28:31], s75 offen nt
    s_add_u32 s75, s75, 0x1000
    buffer_load_dwordx4 v[176:179], v4, s[28:31], s75 offen nt
    v_add_f32_dpp v48, v48, v48 row_ror:8 row_mask:0xf bank_mask:0x3
    v_add_f32_dpp v49, v49, v49 row_ror:8 row_mask:0xf bank_mask:0x3
    s_nop 0
    v_add_f32_dpp v48, v50, v50 row_ror:8 row_mask:0xf bank_mask:0xc
    v_add_f32_dpp v49, v51, v51 row_ror:8 row_mask:0xf bank_mask:0xc
    s_nop 0
    v_add_f32_dpp v112, v48, v48 row_shl:4 row_mask:0xf bank_mask:0x5
    s_nop 1
    v_add_f32_dpp v112, v49, v49 row_shr:4 row_mask:0xf bank_mask:0xa
    s_nop 1
    v_add_f32_dpp v112, v112, v112 quad_perm:[1,0,3,2] row_mask:0xf bank_mask:0xf
    s_nop 1
    v_add_f32_dpp v112, v112, v112 quad_perm:[2,3,0,1] row_mask:0xf bank_mask:0xf
    s_movk_i32 s78, 20480
    v_lshlrev_b32 v18, 4, v3
    v_mad_u32_u24 v18, v2, s78, v18
    s_lshl_b32 s10, s73, 6
    s_add_u32 s10, s10, s72
    s_mul_i32 s10, s10, 2560
    buffer_load_dwordx4 a[0:3], v18, s[40:43], s10 offen offset:0
    buffer_load_dwordx4 a[4:7], v18, s[40:43], s10 offen offset:256
    s_waitcnt vmcnt(7)
    v_dot2_f32_bf16 v48, v144, v92, 0
    v_dot2_f32_bf16 v49, v148, v92, 0
    v_dot2_f32_bf16 v50, v152, v92, 0
    v_dot2_f32_bf16 v51, v156, v92, 0
    v_dot2c_f32_bf16 v48, v145, v93
    v_dot2c_f32_bf16 v49, v149, v93
    v_dot2c_f32_bf16 v50, v153, v93
    v_dot2c_f32_bf16 v51, v157, v93
    v_dot2c_f32_bf16 v48, v146, v94
    v_dot2c_f32_bf16 v49, v150, v94
    v_dot2c_f32_bf16 v50, v154, v94
    v_dot2c_f32_bf16 v51, v158, v94
    v_dot2c_f32_bf16 v48, v147, v95
    v_dot2c_f32_bf16 v49, v151, v95
    v_dot2c_f32_bf16 v50, v155, v95
    v_dot2c_f32_bf16 v51, v159, v95
    s_add_u32 s75, s75, 0x1000
    buffer_load_dwordx4 v[180:183], v4, s[28:31], s75 offen nt
    s_add_u32 s75, s75, 0x1000
    buffer_load_dwordx4 v[184:187], v4, s[28:31], s75 offen nt
    s_add_u32 s75, s75, 0x1000
    buffer_load_dwordx4 v[188:191], v4, s[28:31], s75 offen nt
    s_add_u32 s75, s75, 0x1000
    buffer_load_dwordx4 v[192:195], v4, s[28:31], s75 offen nt
    v_add_f32_dpp v48, v48, v48 row_ror:8 row_mask:0xf bank_mask:0x3
    v_add_f32_dpp v49, v49, v49 row_ror:8 row_mask:0xf bank_mask:0x3
    s_nop 0
    v_add_f32_dpp v48, v50, v50 row_ror:8 row_mask:0xf bank_mask:0xc
    v_add_f32_dpp v49, v51, v51 row_ror:8 row_mask:0xf bank_mask:0xc
    s_nop 0
    v_add_f32_dpp v113, v48, v48 row_shl:4 row_mask:0xf bank_mask:0x5
    s_nop 1
    v_add_f32_dpp v113, v49, v49 row_shr:4 row_mask:0xf bank_mask:0xa
    s_nop 1
    v_add_f32_dpp v113, v113, v113 quad_perm:[1,0,3,2] row_mask:0xf bank_mask:0xf
    s_nop 1
    v_add_f32_dpp v113, v113, v113 quad_perm:[2,3,0,1] row_mask:0xf bank_mask:0xf
    v_cvt_pk_bf16_f32 v48, v112, v113
    v_lshlrev_b32 v112, 16, v48
    v_and_b32 v113, 0xffff0000, v48
    v_mul_f32 v112, 0x3db504f3, v112
    v_mul_f32 v113, 0x3db504f3, v113
    v_cvt_pk_bf16_f32 v48, v112, v113
    v_lshlrev_b32 v112, 16, v48
    v_and_b32 v113, 0xffff0000, v48
    v_max3_f32 v14, v112, v113, v14
    buffer_load_dwordx4 a[8:11], v18, s[40:43], s10 offen offset:512
    buffer_load_dwordx4 a[12:15], v18, s[40:43], s10 offen offset:768
    s_waitcnt vmcnt(9)
    v_dot2_f32_bf16 v48, v160, v92, 0
    v_dot2_f32_bf16 v49, v164, v92, 0
    v_dot2_f32_bf16 v50, v168, v92, 0
    v_dot2_f32_bf16 v51, v172, v92, 0
    v_dot2c_f32_bf16 v48, v161, v93
    v_dot2c_f32_bf16 v49, v165, v93
    v_dot2c_f32_bf16 v50, v169, v93
    v_dot2c_f32_bf16 v51, v173, v93
    v_dot2c_f32_bf16 v48, v162, v94
    v_dot2c_f32_bf16 v49, v166, v94
    v_dot2c_f32_bf16 v50, v170, v94
    v_dot2c_f32_bf16 v51, v174, v94
    v_dot2c_f32_bf16 v48, v163, v95
    v_dot2c_f32_bf16 v49, v167, v95
    v_dot2c_f32_bf16 v50, v171, v95
    v_dot2c_f32_bf16 v51, v175, v95
    s_add_u32 s75, s75, 0x1000
    buffer_load_dwordx4 v[196:199], v4, s[28:31], s75 offen nt
    s_add_u32 s75, s75, 0x1000
    buffer_load_dwordx4 v[200:203], v4, s[28:31], s75 offen nt
    s_add_u32 s75, s75, 0x1000
    buffer_load_dwordx4 v[204:207], v4, s[28:31], s75 offen nt
    s_add_u32 s75, s75, 0x1000
    buffer_load_dwordx4 v[208:211], v4, s[28:31], s75 offen nt
    v_add_f32_dpp v48, v48, v48 row_ror:8 row_mask:0xf bank_mask:0x3
    v_add_f32_dpp v49, v49, v49 row_ror:8 row_mask:0xf bank_mask:0x3
    s_nop 0
    v_add_f32_dpp v48, v50, v50 row_ror:8 row_mask:0xf bank_mask:0xc
    v_add_f32_dpp v49, v51, v51 row_ror:8 row_mask:0xf bank_mask:0xc
    s_nop 0
    v_add_f32_dpp v114, v48, v48 row_shl:4 row_mask:0xf bank_mask:0x5
    s_nop 1
    v_add_f32_dpp v114, v49, v49 row_shr:4 row_mask:0xf bank_mask:0xa
    s_nop 1
    v_add_f32_dpp v114, v114, v114 quad_perm:[1,0,3,2] row_mask:0xf bank_mask:0xf
    s_nop 1
    v_add_f32_dpp v114, v114, v114 quad_perm:[2,3,0,1] row_mask:0xf bank_mask:0xf
    buffer_load_dwordx4 a[16:19], v18, s[40:43], s10 offen offset:1024
    buffer_load_dwordx4 a[20:23], v18, s[40:43], s10 offen offset:1280
    s_waitcnt vmcnt(9)
    v_dot2_f32_bf16 v48, v176, v92, 0
    v_dot2_f32_bf16 v49, v180, v92, 0
    v_dot2_f32_bf16 v50, v184, v92, 0
    v_dot2_f32_bf16 v51, v188, v92, 0
    v_dot2c_f32_bf16 v48, v177, v93
    v_dot2c_f32_bf16 v49, v181, v93
    v_dot2c_f32_bf16 v50, v185, v93
    v_dot2c_f32_bf16 v51, v189, v93
    v_dot2c_f32_bf16 v48, v178, v94
    v_dot2c_f32_bf16 v49, v182, v94
    v_dot2c_f32_bf16 v50, v186, v94
    v_dot2c_f32_bf16 v51, v190, v94
    v_dot2c_f32_bf16 v48, v179, v95
    v_dot2c_f32_bf16 v49, v183, v95
    v_dot2c_f32_bf16 v50, v187, v95
    v_dot2c_f32_bf16 v51, v191, v95
    s_add_u32 s75, s75, 0x1000
    buffer_load_dwordx4 v[212:215], v4, s[28:31], s75 offen nt
    s_add_u32 s75, s75, 0x1000
    buffer_load_dwordx4 v[216:219], v4, s[28:31], s75 offen nt
    s_add_u32 s75, s75, 0x1000
    buffer_load_dwordx4 v[220:223], v4, s[28:31], s75 offen nt
    s_add_u32 s75, s75, 0x1000
    buffer_load_dwordx4 v[224:227], v4, s[28:31], s75 offen nt
    v_add_f32_dpp v48, v48, v48 row_ror:8 row_mask:0xf bank_mask:0x3
    v_add_f32_dpp v49, v49, v49 row_ror:8 row_mask:0xf bank_mask:0x3
    s_nop 0
    v_add_f32_dpp v48, v50, v50 row_ror:8 row_mask:0xf bank_mask:0xc
    v_add_f32_dpp v49, v51, v51 row_ror:8 row_mask:0xf bank_mask:0xc
    s_nop 0
    v_add_f32_dpp v115, v48, v48 row_shl:4 row_mask:0xf bank_mask:0x5
    s_nop 1
    v_add_f32_dpp v115, v49, v49 row_shr:4 row_mask:0xf bank_mask:0xa
    s_nop 1
    v_add_f32_dpp v115, v115, v115 quad_perm:[1,0,3,2] row_mask:0xf bank_mask:0xf
    s_nop 1
    v_add_f32_dpp v115, v115, v115 quad_perm:[2,3,0,1] row_mask:0xf bank_mask:0xf
    v_cvt_pk_bf16_f32 v48, v114, v115
    v_lshlrev_b32 v114, 16, v48
    v_and_b32 v115, 0xffff0000, v48
    v_mul_f32 v114, 0x3db504f3, v114
    v_mul_f32 v115, 0x3db504f3, v115
    v_cvt_pk_bf16_f32 v48, v114, v115
    v_lshlrev_b32 v114, 16, v48
    v_and_b32 v115, 0xffff0000, v48
    v_max3_f32 v14, v114, v115, v14
    buffer_load_dwordx4 a[24:27], v18, s[40:43], s10 offen offset:1536
    buffer_load_dwordx4 a[28:31], v18, s[40:43], s10 offen offset:1792
    s_waitcnt vmcnt(9)
    v_dot2_f32_bf16 v48, v192, v92, 0
    v_dot2_f32_bf16 v49, v196, v92, 0
    v_dot2_f32_bf16 v50, v200, v92, 0
    v_dot2_f32_bf16 v51, v204, v92, 0
    v_dot2c_f32_bf16 v48, v193, v93
    v_dot2c_f32_bf16 v49, v197, v93
    v_dot2c_f32_bf16 v50, v201, v93
    v_dot2c_f32_bf16 v51, v205, v93
    v_dot2c_f32_bf16 v48, v194, v94
    v_dot2c_f32_bf16 v49, v198, v94
    v_dot2c_f32_bf16 v50, v202, v94
    v_dot2c_f32_bf16 v51, v206, v94
    v_dot2c_f32_bf16 v48, v195, v95
    v_dot2c_f32_bf16 v49, v199, v95
    v_dot2c_f32_bf16 v50, v203, v95
    v_dot2c_f32_bf16 v51, v207, v95
    s_add_u32 s75, s75, 0x1000
    buffer_load_dwordx4 v[228:231], v4, s[28:31], s75 offen nt
    s_add_u32 s75, s75, 0x1000
    buffer_load_dwordx4 v[232:235], v4, s[28:31], s75 offen nt
    s_add_u32 s75, s75, 0x1000
    buffer_load_dwordx4 v[236:239], v4, s[28:31], s75 offen nt
    s_add_u32 s75, s75, 0x1000
    buffer_load_dwordx4 v[240:243], v4, s[28:31], s75 offen nt
    v_add_f32_dpp v48, v48, v48 row_ror:8 row_mask:0xf bank_mask:0x3
    v_add_f32_dpp v49, v49, v49 row_ror:8 row_mask:0xf bank_mask:0x3
    s_nop 0
    v_add_f32_dpp v48, v50, v50 row_ror:8 row_mask:0xf bank_mask:0xc
    v_add_f32_dpp v49, v51, v51 row_ror:8 row_mask:0xf bank_mask:0xc
    s_nop 0
    v_add_f32_dpp v116, v48, v48 row_shl:4 row_mask:0xf bank_mask:0x5
    s_nop 1
    v_add_f32_dpp v116, v49, v49 row_shr:4 row_mask:0xf bank_mask:0xa
    s_nop 1
    v_add_f32_dpp v116, v116, v116 quad_perm:[1,0,3,2] row_mask:0xf bank_mask:0xf
    s_nop 1
    v_add_f32_dpp v116, v116, v116 quad_perm:[2,3,0,1] row_mask:0xf bank_mask:0xf
    buffer_load_dwordx4 a[32:35], v18, s[40:43], s10 offen offset:2048
    buffer_load_dwordx4 a[36:39], v18, s[40:43], s10 offen offset:2304
    s_waitcnt vmcnt(9)
    v_dot2_f32_bf16 v48, v208, v92, 0
    v_dot2_f32_bf16 v49, v212, v92, 0
    v_dot2_f32_bf16 v50, v216, v92, 0
    v_dot2_f32_bf16 v51, v220, v92, 0
    v_dot2c_f32_bf16 v48, v209, v93
    v_dot2c_f32_bf16 v49, v213, v93
    v_dot2c_f32_bf16 v50, v217, v93
    v_dot2c_f32_bf16 v51, v221, v93
    v_dot2c_f32_bf16 v48, v210, v94
    v_dot2c_f32_bf16 v49, v214, v94
    v_dot2c_f32_bf16 v50, v218, v94
    v_dot2c_f32_bf16 v51, v222, v94
    v_dot2c_f32_bf16 v48, v211, v95
    v_dot2c_f32_bf16 v49, v215, v95
    v_dot2c_f32_bf16 v50, v219, v95
    v_dot2c_f32_bf16 v51, v223, v95
    s_add_u32 s75, s75, 0x1000
    buffer_load_dwordx4 v[244:247], v4, s[28:31], s75 offen nt
    s_add_u32 s75, s75, 0x1000
    buffer_load_dwordx4 v[248:251], v4, s[28:31], s75 offen nt
    s_add_u32 s75, s75, 0x1000
    buffer_load_dwordx4 v[252:255], v4, s[28:31], s75 offen nt
    s_add_u32 s75, s75, 0x1000
    s_and_b32 s75, s75, 0x7ffff
    buffer_load_dwordx4 v[128:131], v4, s[28:31], s75 offen nt
    v_add_f32_dpp v48, v48, v48 row_ror:8 row_mask:0xf bank_mask:0x3
    v_add_f32_dpp v49, v49, v49 row_ror:8 row_mask:0xf bank_mask:0x3
    s_nop 0
    v_add_f32_dpp v48, v50, v50 row_ror:8 row_mask:0xf bank_mask:0xc
    v_add_f32_dpp v49, v51, v51 row_ror:8 row_mask:0xf bank_mask:0xc
    s_nop 0
    v_add_f32_dpp v117, v48, v48 row_shl:4 row_mask:0xf bank_mask:0x5
    s_nop 1
    v_add_f32_dpp v117, v49, v49 row_shr:4 row_mask:0xf bank_mask:0xa
    s_nop 1
    v_add_f32_dpp v117, v117, v117 quad_perm:[1,0,3,2] row_mask:0xf bank_mask:0xf
    s_nop 1
    v_add_f32_dpp v117, v117, v117 quad_perm:[2,3,0,1] row_mask:0xf bank_mask:0xf
    v_cvt_pk_bf16_f32 v48, v116, v117
    v_lshlrev_b32 v116, 16, v48
    v_and_b32 v117, 0xffff0000, v48
    v_mul_f32 v116, 0x3db504f3, v116
    v_mul_f32 v117, 0x3db504f3, v117
    v_cvt_pk_bf16_f32 v48, v116, v117
    v_lshlrev_b32 v116, 16, v48
    v_and_b32 v117, 0xffff0000, v48
    v_max3_f32 v14, v116, v117, v14
    s_add_u32 s10, s10, 10240
    buffer_load_dwordx4 a[40:43], v18, s[40:43], s10 offen offset:0
    buffer_load_dwordx4 a[44:47], v18, s[40:43], s10 offen offset:256
    s_waitcnt vmcnt(9)
    v_dot2_f32_bf16 v48, v224, v92, 0
    v_dot2_f32_bf16 v49, v228, v92, 0
    v_dot2_f32_bf16 v50, v232, v92, 0
    v_dot2_f32_bf16 v51, v236, v92, 0
    v_dot2c_f32_bf16 v48, v225, v93
    v_dot2c_f32_bf16 v49, v229, v93
    v_dot2c_f32_bf16 v50, v233, v93
    v_dot2c_f32_bf16 v51, v237, v93
    v_dot2c_f32_bf16 v48, v226, v94
    v_dot2c_f32_bf16 v49, v230, v94
    v_dot2c_f32_bf16 v50, v234, v94
    v_dot2c_f32_bf16 v51, v238, v94
    v_dot2c_f32_bf16 v48, v227, v95
    v_dot2c_f32_bf16 v49, v231, v95
    v_dot2c_f32_bf16 v50, v235, v95
    v_dot2c_f32_bf16 v51, v239, v95
    s_add_u32 s75, s75, 0x1000
    buffer_load_dwordx4 v[132:135], v4, s[28:31], s75 offen nt
    s_add_u32 s75, s75, 0x1000
    buffer_load_dwordx4 v[136:139], v4, s[28:31], s75 offen nt
    s_add_u32 s75, s75, 0x1000
    buffer_load_dwordx4 v[140:143], v4, s[28:31], s75 offen nt
    s_add_u32 s75, s75, 0x1000
    buffer_load_dwordx4 v[144:147], v4, s[28:31], s75 offen nt
    v_add_f32_dpp v48, v48, v48 row_ror:8 row_mask:0xf bank_mask:0x3
    v_add_f32_dpp v49, v49, v49 row_ror:8 row_mask:0xf bank_mask:0x3
    s_nop 0
    v_add_f32_dpp v48, v50, v50 row_ror:8 row_mask:0xf bank_mask:0xc
    v_add_f32_dpp v49, v51, v51 row_ror:8 row_mask:0xf bank_mask:0xc
    s_nop 0
    v_add_f32_dpp v118, v48, v48 row_shl:4 row_mask:0xf bank_mask:0x5
    s_nop 1
    v_add_f32_dpp v118, v49, v49 row_shr:4 row_mask:0xf bank_mask:0xa
    s_nop 1
    v_add_f32_dpp v118, v118, v118 quad_perm:[1,0,3,2] row_mask:0xf bank_mask:0xf
    s_nop 1
    v_add_f32_dpp v118, v118, v118 quad_perm:[2,3,0,1] row_mask:0xf bank_mask:0xf
    buffer_load_dwordx4 a[48:51], v18, s[40:43], s10 offen offset:512
    buffer_load_dwordx4 a[52:55], v18, s[40:43], s10 offen offset:768
    s_waitcnt vmcnt(9)
    v_dot2_f32_bf16 v48, v240, v92, 0
    v_dot2_f32_bf16 v49, v244, v92, 0
    v_dot2_f32_bf16 v50, v248, v92, 0
    v_dot2_f32_bf16 v51, v252, v92, 0
    v_dot2c_f32_bf16 v48, v241, v93
    v_dot2c_f32_bf16 v49, v245, v93
    v_dot2c_f32_bf16 v50, v249, v93
    v_dot2c_f32_bf16 v51, v253, v93
    v_dot2c_f32_bf16 v48, v242, v94
    v_dot2c_f32_bf16 v49, v246, v94
    v_dot2c_f32_bf16 v50, v250, v94
    v_dot2c_f32_bf16 v51, v254, v94
    v_dot2c_f32_bf16 v48, v243, v95
    v_dot2c_f32_bf16 v49, v247, v95
    v_dot2c_f32_bf16 v50, v251, v95
    v_dot2c_f32_bf16 v51, v255, v95
    s_add_u32 s75, s75, 0x1000
    buffer_load_dwordx4 v[148:151], v4, s[28:31], s75 offen nt
    s_add_u32 s75, s75, 0x1000
    buffer_load_dwordx4 v[152:155], v4, s[28:31], s75 offen nt
    s_add_u32 s75, s75, 0x1000
    buffer_load_dwordx4 v[156:159], v4, s[28:31], s75 offen nt
    s_add_u32 s75, s75, 0x1000
    buffer_load_dwordx4 v[160:163], v4, s[28:31], s75 offen nt
    v_add_f32_dpp v48, v48, v48 row_ror:8 row_mask:0xf bank_mask:0x3
    v_add_f32_dpp v49, v49, v49 row_ror:8 row_mask:0xf bank_mask:0x3
    s_nop 0
    v_add_f32_dpp v48, v50, v50 row_ror:8 row_mask:0xf bank_mask:0xc
    v_add_f32_dpp v49, v51, v51 row_ror:8 row_mask:0xf bank_mask:0xc
    s_nop 0
    v_add_f32_dpp v119, v48, v48 row_shl:4 row_mask:0xf bank_mask:0x5
    s_nop 1
    v_add_f32_dpp v119, v49, v49 row_shr:4 row_mask:0xf bank_mask:0xa
    s_nop 1
    v_add_f32_dpp v119, v119, v119 quad_perm:[1,0,3,2] row_mask:0xf bank_mask:0xf
    s_nop 1
    v_add_f32_dpp v119, v119, v119 quad_perm:[2,3,0,1] row_mask:0xf bank_mask:0xf
    v_cvt_pk_bf16_f32 v48, v118, v119
    v_lshlrev_b32 v118, 16, v48
    v_and_b32 v119, 0xffff0000, v48
    v_mul_f32 v118, 0x3db504f3, v118
    v_mul_f32 v119, 0x3db504f3, v119
    v_cvt_pk_bf16_f32 v48, v118, v119
    v_lshlrev_b32 v118, 16, v48
    v_and_b32 v119, 0xffff0000, v48
    v_max3_f32 v14, v118, v119, v14
    buffer_load_dwordx4 a[56:59], v18, s[40:43], s10 offen offset:1024
    buffer_load_dwordx4 a[60:63], v18, s[40:43], s10 offen offset:1280
    s_waitcnt vmcnt(9)
    v_dot2_f32_bf16 v48, v128, v92, 0
    v_dot2_f32_bf16 v49, v132, v92, 0
    v_dot2_f32_bf16 v50, v136, v92, 0
    v_dot2_f32_bf16 v51, v140, v92, 0
    v_dot2c_f32_bf16 v48, v129, v93
    v_dot2c_f32_bf16 v49, v133, v93
    v_dot2c_f32_bf16 v50, v137, v93
    v_dot2c_f32_bf16 v51, v141, v93
    v_dot2c_f32_bf16 v48, v130, v94
    v_dot2c_f32_bf16 v49, v134, v94
    v_dot2c_f32_bf16 v50, v138, v94
    v_dot2c_f32_bf16 v51, v142, v94
    v_dot2c_f32_bf16 v48, v131, v95
    v_dot2c_f32_bf16 v49, v135, v95
    v_dot2c_f32_bf16 v50, v139, v95
    v_dot2c_f32_bf16 v51, v143, v95
    s_add_u32 s75, s75, 0x1000
    buffer_load_dwordx4 v[164:167], v4, s[28:31], s75 offen nt
    s_add_u32 s75, s75, 0x1000
    buffer_load_dwordx4 v[168:171], v4, s[28:31], s75 offen nt
    s_add_u32 s75, s75, 0x1000
    buffer_load_dwordx4 v[172:175], v4, s[28:31], s75 offen nt
    s_add_u32 s75, s75, 0x1000
    buffer_load_dwordx4 v[176:179], v4, s[28:31], s75 offen nt
    v_add_f32_dpp v48, v48, v48 row_ror:8 row_mask:0xf bank_mask:0x3
    v_add_f32_dpp v49, v49, v49 row_ror:8 row_mask:0xf bank_mask:0x3
    s_nop 0
    v_add_f32_dpp v48, v50, v50 row_ror:8 row_mask:0xf bank_mask:0xc
    v_add_f32_dpp v49, v51, v51 row_ror:8 row_mask:0xf bank_mask:0xc
    s_nop 0
    v_add_f32_dpp v120, v48, v48 row_shl:4 row_mask:0xf bank_mask:0x5
    s_nop 1
    v_add_f32_dpp v120, v49, v49 row_shr:4 row_mask:0xf bank_mask:0xa
    s_nop 1
    v_add_f32_dpp v120, v120, v120 quad_perm:[1,0,3,2] row_mask:0xf bank_mask:0xf
    s_nop 1
    v_add_f32_dpp v120, v120, v120 quad_perm:[2,3,0,1] row_mask:0xf bank_mask:0xf
    buffer_load_dwordx4 a[64:67], v18, s[40:43], s10 offen offset:1536
    buffer_load_dwordx4 a[68:71], v18, s[40:43], s10 offen offset:1792
    s_waitcnt vmcnt(9)
    v_dot2_f32_bf16 v48, v144, v92, 0
    v_dot2_f32_bf16 v49, v148, v92, 0
    v_dot2_f32_bf16 v50, v152, v92, 0
    v_dot2_f32_bf16 v51, v156, v92, 0
    v_dot2c_f32_bf16 v48, v145, v93
    v_dot2c_f32_bf16 v49, v149, v93
    v_dot2c_f32_bf16 v50, v153, v93
    v_dot2c_f32_bf16 v51, v157, v93
    v_dot2c_f32_bf16 v48, v146, v94
    v_dot2c_f32_bf16 v49, v150, v94
    v_dot2c_f32_bf16 v50, v154, v94
    v_dot2c_f32_bf16 v51, v158, v94
    v_dot2c_f32_bf16 v48, v147, v95
    v_dot2c_f32_bf16 v49, v151, v95
    v_dot2c_f32_bf16 v50, v155, v95
    v_dot2c_f32_bf16 v51, v159, v95
    s_add_u32 s75, s75, 0x1000
    buffer_load_dwordx4 v[180:183], v4, s[28:31], s75 offen nt
    s_add_u32 s75, s75, 0x1000
    buffer_load_dwordx4 v[184:187], v4, s[28:31], s75 offen nt
    s_add_u32 s75, s75, 0x1000
    buffer_load_dwordx4 v[188:191], v4, s[28:31], s75 offen nt
    s_add_u32 s75, s75, 0x1000
    buffer_load_dwordx4 v[192:195], v4, s[28:31], s75 offen nt
    v_add_f32_dpp v48, v48, v48 row_ror:8 row_mask:0xf bank_mask:0x3
    v_add_f32_dpp v49, v49, v49 row_ror:8 row_mask:0xf bank_mask:0x3
    s_nop 0
    v_add_f32_dpp v48, v50, v50 row_ror:8 row_mask:0xf bank_mask:0xc
    v_add_f32_dpp v49, v51, v51 row_ror:8 row_mask:0xf bank_mask:0xc
    s_nop 0
    v_add_f32_dpp v121, v48, v48 row_shl:4 row_mask:0xf bank_mask:0x5
    s_nop 1
    v_add_f32_dpp v121, v49, v49 row_shr:4 row_mask:0xf bank_mask:0xa
    s_nop 1
    v_add_f32_dpp v121, v121, v121 quad_perm:[1,0,3,2] row_mask:0xf bank_mask:0xf
    s_nop 1
    v_add_f32_dpp v121, v121, v121 quad_perm:[2,3,0,1] row_mask:0xf bank_mask:0xf
    v_cvt_pk_bf16_f32 v48, v120, v121
    v_lshlrev_b32 v120, 16, v48
    v_and_b32 v121, 0xffff0000, v48
    v_mul_f32 v120, 0x3db504f3, v120
    v_mul_f32 v121, 0x3db504f3, v121
    v_cvt_pk_bf16_f32 v48, v120, v121
    v_lshlrev_b32 v120, 16, v48
    v_and_b32 v121, 0xffff0000, v48
    v_max3_f32 v14, v120, v121, v14
    buffer_load_dwordx4 a[72:75], v18, s[40:43], s10 offen offset:2048
    buffer_load_dwordx4 a[76:79], v18, s[40:43], s10 offen offset:2304
    buffer_load_dwordx4 v[32:35], v21, s[52:55], 0 offen sc1
    s_waitcnt vmcnt(10)
    v_dot2_f32_bf16 v48, v160, v92, 0
    v_dot2_f32_bf16 v49, v164, v92, 0
    v_dot2_f32_bf16 v50, v168, v92, 0
    v_dot2_f32_bf16 v51, v172, v92, 0
    v_dot2c_f32_bf16 v48, v161, v93
    v_dot2c_f32_bf16 v49, v165, v93
    v_dot2c_f32_bf16 v50, v169, v93
    v_dot2c_f32_bf16 v51, v173, v93
    v_dot2c_f32_bf16 v48, v162, v94
    v_dot2c_f32_bf16 v49, v166, v94
    v_dot2c_f32_bf16 v50, v170, v94
    v_dot2c_f32_bf16 v51, v174, v94
    v_dot2c_f32_bf16 v48, v163, v95
    v_dot2c_f32_bf16 v49, v167, v95
    v_dot2c_f32_bf16 v50, v171, v95
    v_dot2c_f32_bf16 v51, v175, v95
    s_add_u32 s75, s75, 0x1000
    buffer_load_dwordx4 v[196:199], v4, s[28:31], s75 offen nt
    s_add_u32 s75, s75, 0x1000
    buffer_load_dwordx4 v[200:203], v4, s[28:31], s75 offen nt
    s_add_u32 s75, s75, 0x1000
    buffer_load_dwordx4 v[204:207], v4, s[28:31], s75 offen nt
    s_add_u32 s75, s75, 0x1000
    buffer_load_dwordx4 v[208:211], v4, s[28:31], s75 offen nt
    v_add_f32_dpp v48, v48, v48 row_ror:8 row_mask:0xf bank_mask:0x3
    v_add_f32_dpp v49, v49, v49 row_ror:8 row_mask:0xf bank_mask:0x3
    s_nop 0
    v_add_f32_dpp v48, v50, v50 row_ror:8 row_mask:0xf bank_mask:0xc
    v_add_f32_dpp v49, v51, v51 row_ror:8 row_mask:0xf bank_mask:0xc
    s_nop 0
    v_add_f32_dpp v122, v48, v48 row_shl:4 row_mask:0xf bank_mask:0x5
    s_nop 1
    v_add_f32_dpp v122, v49, v49 row_shr:4 row_mask:0xf bank_mask:0xa
    s_nop 1
    v_add_f32_dpp v122, v122, v122 quad_perm:[1,0,3,2] row_mask:0xf bank_mask:0xf
    s_nop 1
    v_add_f32_dpp v122, v122, v122 quad_perm:[2,3,0,1] row_mask:0xf bank_mask:0xf
    s_add_u32 s10, s10, 71680
    buffer_load_dwordx4 a[80:83], v18, s[40:43], s10 offen offset:0
    buffer_load_dwordx4 a[84:87], v18, s[40:43], s10 offen offset:256
    s_waitcnt vmcnt(10)
    v_dot2_f32_bf16 v48, v176, v92, 0
    v_dot2_f32_bf16 v49, v180, v92, 0
    v_dot2_f32_bf16 v50, v184, v92, 0
    v_dot2_f32_bf16 v51, v188, v92, 0
    v_dot2c_f32_bf16 v48, v177, v93
    v_dot2c_f32_bf16 v49, v181, v93
    v_dot2c_f32_bf16 v50, v185, v93
    v_dot2c_f32_bf16 v51, v189, v93
    v_dot2c_f32_bf16 v48, v178, v94
    v_dot2c_f32_bf16 v49, v182, v94
    v_dot2c_f32_bf16 v50, v186, v94
    v_dot2c_f32_bf16 v51, v190, v94
    v_dot2c_f32_bf16 v48, v179, v95
    v_dot2c_f32_bf16 v49, v183, v95
    v_dot2c_f32_bf16 v50, v187, v95
    v_dot2c_f32_bf16 v51, v191, v95
    s_add_u32 s75, s75, 0x1000
    buffer_load_dwordx4 v[212:215], v4, s[28:31], s75 offen nt
    s_add_u32 s75, s75, 0x1000
    buffer_load_dwordx4 v[216:219], v4, s[28:31], s75 offen nt
    s_add_u32 s75, s75, 0x1000
    buffer_load_dwordx4 v[220:223], v4, s[28:31], s75 offen nt
    s_add_u32 s75, s75, 0x1000
    buffer_load_dwordx4 v[224:227], v4, s[28:31], s75 offen nt
    v_add_f32_dpp v48, v48, v48 row_ror:8 row_mask:0xf bank_mask:0x3
    v_add_f32_dpp v49, v49, v49 row_ror:8 row_mask:0xf bank_mask:0x3
    s_nop 0
    v_add_f32_dpp v48, v50, v50 row_ror:8 row_mask:0xf bank_mask:0xc
    v_add_f32_dpp v49, v51, v51 row_ror:8 row_mask:0xf bank_mask:0xc
    s_nop 0
    v_add_f32_dpp v123, v48, v48 row_shl:4 row_mask:0xf bank_mask:0x5
    s_nop 1
    v_add_f32_dpp v123, v49, v49 row_shr:4 row_mask:0xf bank_mask:0xa
    s_nop 1
    v_add_f32_dpp v123, v123, v123 quad_perm:[1,0,3,2] row_mask:0xf bank_mask:0xf
    s_nop 1
    v_add_f32_dpp v123, v123, v123 quad_perm:[2,3,0,1] row_mask:0xf bank_mask:0xf
    v_cvt_pk_bf16_f32 v48, v122, v123
    v_lshlrev_b32 v122, 16, v48
    v_and_b32 v123, 0xffff0000, v48
    v_mul_f32 v122, 0x3db504f3, v122
    v_mul_f32 v123, 0x3db504f3, v123
    v_cvt_pk_bf16_f32 v48, v122, v123
    v_lshlrev_b32 v122, 16, v48
    v_and_b32 v123, 0xffff0000, v48
    v_max3_f32 v14, v122, v123, v14
    buffer_load_dwordx4 a[88:91], v18, s[40:43], s10 offen offset:512
    buffer_load_dwordx4 a[92:95], v18, s[40:43], s10 offen offset:768
    s_waitcnt vmcnt(9)
    v_dot2_f32_bf16 v48, v192, v92, 0
    v_dot2_f32_bf16 v49, v196, v92, 0
    v_dot2_f32_bf16 v50, v200, v92, 0
    v_dot2_f32_bf16 v51, v204, v92, 0
    v_dot2c_f32_bf16 v48, v193, v93
    v_dot2c_f32_bf16 v49, v197, v93
    v_dot2c_f32_bf16 v50, v201, v93
    v_dot2c_f32_bf16 v51, v205, v93
    v_dot2c_f32_bf16 v48, v194, v94
    v_dot2c_f32_bf16 v49, v198, v94
    v_dot2c_f32_bf16 v50, v202, v94
    v_dot2c_f32_bf16 v51, v206, v94
    v_dot2c_f32_bf16 v48, v195, v95
    v_dot2c_f32_bf16 v49, v199, v95
    v_dot2c_f32_bf16 v50, v203, v95
    v_dot2c_f32_bf16 v51, v207, v95
    s_add_u32 s75, s75, 0x1000
    buffer_load_dwordx4 v[228:231], v4, s[28:31], s75 offen nt
    s_add_u32 s75, s75, 0x1000
    buffer_load_dwordx4 v[232:235], v4, s[28:31], s75 offen nt
    s_add_u32 s75, s75, 0x1000
    buffer_load_dwordx4 v[236:239], v4, s[28:31], s75 offen nt
    s_add_u32 s75, s75, 0x1000
    buffer_load_dwordx4 v[240:243], v4, s[28:31], s75 offen nt
    v_add_f32_dpp v48, v48, v48 row_ror:8 row_mask:0xf bank_mask:0x3
    v_add_f32_dpp v49, v49, v49 row_ror:8 row_mask:0xf bank_mask:0x3
    s_nop 0
    v_add_f32_dpp v48, v50, v50 row_ror:8 row_mask:0xf bank_mask:0xc
    v_add_f32_dpp v49, v51, v51 row_ror:8 row_mask:0xf bank_mask:0xc
    s_nop 0
    v_add_f32_dpp v124, v48, v48 row_shl:4 row_mask:0xf bank_mask:0x5
    s_nop 1
    v_add_f32_dpp v124, v49, v49 row_shr:4 row_mask:0xf bank_mask:0xa
    s_nop 1
    v_add_f32_dpp v124, v124, v124 quad_perm:[1,0,3,2] row_mask:0xf bank_mask:0xf
    s_nop 1
    v_add_f32_dpp v124, v124, v124 quad_perm:[2,3,0,1] row_mask:0xf bank_mask:0xf
    buffer_load_dwordx4 a[96:99], v18, s[40:43], s10 offen offset:1024
    buffer_load_dwordx4 a[100:103], v18, s[40:43], s10 offen offset:1280
    s_waitcnt vmcnt(9)
    v_dot2_f32_bf16 v48, v208, v92, 0
    v_dot2_f32_bf16 v49, v212, v92, 0
    v_dot2_f32_bf16 v50, v216, v92, 0
    v_dot2_f32_bf16 v51, v220, v92, 0
    v_dot2c_f32_bf16 v48, v209, v93
    v_dot2c_f32_bf16 v49, v213, v93
    v_dot2c_f32_bf16 v50, v217, v93
    v_dot2c_f32_bf16 v51, v221, v93
    v_dot2c_f32_bf16 v48, v210, v94
    v_dot2c_f32_bf16 v49, v214, v94
    v_dot2c_f32_bf16 v50, v218, v94
    v_dot2c_f32_bf16 v51, v222, v94
    v_dot2c_f32_bf16 v48, v211, v95
    v_dot2c_f32_bf16 v49, v215, v95
    v_dot2c_f32_bf16 v50, v219, v95
    v_dot2c_f32_bf16 v51, v223, v95
    s_add_u32 s75, s75, 0x1000
    buffer_load_dwordx4 v[244:247], v4, s[28:31], s75 offen nt
    s_add_u32 s75, s75, 0x1000
    buffer_load_dwordx4 v[248:251], v4, s[28:31], s75 offen nt
    s_add_u32 s75, s75, 0x1000
    buffer_load_dwordx4 v[252:255], v4, s[28:31], s75 offen nt
    s_mov_b32 s82, s74
    buffer_load_dwordx4 v[128:131], v4, s[32:35], s82 offen nt
    v_add_f32_dpp v48, v48, v48 row_ror:8 row_mask:0xf bank_mask:0x3
    v_add_f32_dpp v49, v49, v49 row_ror:8 row_mask:0xf bank_mask:0x3
    s_nop 0
    v_add_f32_dpp v48, v50, v50 row_ror:8 row_mask:0xf bank_mask:0xc
    v_add_f32_dpp v49, v51, v51 row_ror:8 row_mask:0xf bank_mask:0xc
    s_nop 0
    v_add_f32_dpp v125, v48, v48 row_shl:4 row_mask:0xf bank_mask:0x5
    s_nop 1
    v_add_f32_dpp v125, v49, v49 row_shr:4 row_mask:0xf bank_mask:0xa
    s_nop 1
    v_add_f32_dpp v125, v125, v125 quad_perm:[1,0,3,2] row_mask:0xf bank_mask:0xf
    s_nop 1
    v_add_f32_dpp v125, v125, v125 quad_perm:[2,3,0,1] row_mask:0xf bank_mask:0xf
    v_cvt_pk_bf16_f32 v48, v124, v125
    v_lshlrev_b32 v124, 16, v48
    v_and_b32 v125, 0xffff0000, v48
    v_mul_f32 v124, 0x3db504f3, v124
    v_mul_f32 v125, 0x3db504f3, v125
    v_cvt_pk_bf16_f32 v48, v124, v125
    v_lshlrev_b32 v124, 16, v48
    v_and_b32 v125, 0xffff0000, v48
    v_max3_f32 v14, v124, v125, v14
    buffer_load_dwordx4 a[104:107], v18, s[40:43], s10 offen offset:1536
    buffer_load_dwordx4 a[108:111], v18, s[40:43], s10 offen offset:1792
    s_waitcnt vmcnt(9)
    v_dot2_f32_bf16 v48, v224, v92, 0
    v_dot2_f32_bf16 v49, v228, v92, 0
    v_dot2_f32_bf16 v50, v232, v92, 0
    v_dot2_f32_bf16 v51, v236, v92, 0
    v_dot2c_f32_bf16 v48, v225, v93
    v_dot2c_f32_bf16 v49, v229, v93
    v_dot2c_f32_bf16 v50, v233, v93
    v_dot2c_f32_bf16 v51, v237, v93
    v_dot2c_f32_bf16 v48, v226, v94
    v_dot2c_f32_bf16 v49, v230, v94
    v_dot2c_f32_bf16 v50, v234, v94
    v_dot2c_f32_bf16 v51, v238, v94
    v_dot2c_f32_bf16 v48, v227, v95
    v_dot2c_f32_bf16 v49, v231, v95
    v_dot2c_f32_bf16 v50, v235, v95
    v_dot2c_f32_bf16 v51, v239, v95
    s_add_u32 s82, s82, 0x1000
    buffer_load_dwordx4 v[132:135], v4, s[32:35], s82 offen nt
    s_add_u32 s82, s82, 0x1000
    buffer_load_dwordx4 v[136:139], v4, s[32:35], s82 offen nt
    s_add_u32 s82, s82, 0x1000
    buffer_load_dwordx4 v[140:143], v4, s[32:35], s82 offen nt
    s_add_u32 s82, s82, 0x1000
    buffer_load_dwordx4 v[144:147], v4, s[32:35], s82 offen nt
    v_add_f32_dpp v48, v48, v48 row_ror:8 row_mask:0xf bank_mask:0x3
    v_add_f32_dpp v49, v49, v49 row_ror:8 row_mask:0xf bank_mask:0x3
    s_nop 0
    v_add_f32_dpp v48, v50, v50 row_ror:8 row_mask:0xf bank_mask:0xc
    v_add_f32_dpp v49, v51, v51 row_ror:8 row_mask:0xf bank_mask:0xc
    s_nop 0
    v_add_f32_dpp v126, v48, v48 row_shl:4 row_mask:0xf bank_mask:0x5
    s_nop 1
    v_add_f32_dpp v126, v49, v49 row_shr:4 row_mask:0xf bank_mask:0xa
    s_nop 1
    v_add_f32_dpp v126, v126, v126 quad_perm:[1,0,3,2] row_mask:0xf bank_mask:0xf
    s_nop 1
    v_add_f32_dpp v126, v126, v126 quad_perm:[2,3,0,1] row_mask:0xf bank_mask:0xf
    buffer_load_dwordx4 a[112:115], v18, s[40:43], s10 offen offset:2048
    buffer_load_dwordx4 a[116:119], v18, s[40:43], s10 offen offset:2304
    s_waitcnt vmcnt(9)
    v_dot2_f32_bf16 v48, v240, v92, 0
    v_dot2_f32_bf16 v49, v244, v92, 0
    v_dot2_f32_bf16 v50, v248, v92, 0
    v_dot2_f32_bf16 v51, v252, v92, 0
    v_dot2c_f32_bf16 v48, v241, v93
    v_dot2c_f32_bf16 v49, v245, v93
    v_dot2c_f32_bf16 v50, v249, v93
    v_dot2c_f32_bf16 v51, v253, v93
    v_dot2c_f32_bf16 v48, v242, v94
    v_dot2c_f32_bf16 v49, v246, v94
    v_dot2c_f32_bf16 v50, v250, v94
    v_dot2c_f32_bf16 v51, v254, v94
    v_dot2c_f32_bf16 v48, v243, v95
    v_dot2c_f32_bf16 v49, v247, v95
    v_dot2c_f32_bf16 v50, v251, v95
    v_dot2c_f32_bf16 v51, v255, v95
    s_add_u32 s82, s82, 0x1000
    buffer_load_dwordx4 v[148:151], v4, s[32:35], s82 offen nt
    s_add_u32 s82, s82, 0x1000
    buffer_load_dwordx4 v[152:155], v4, s[32:35], s82 offen nt
    v_add_f32_dpp v48, v48, v48 row_ror:8 row_mask:0xf bank_mask:0x3
    v_add_f32_dpp v49, v49, v49 row_ror:8 row_mask:0xf bank_mask:0x3
    s_nop 0
    v_add_f32_dpp v48, v50, v50 row_ror:8 row_mask:0xf bank_mask:0xc
    v_add_f32_dpp v49, v51, v51 row_ror:8 row_mask:0xf bank_mask:0xc
    s_nop 0
    v_add_f32_dpp v127, v48, v48 row_shl:4 row_mask:0xf bank_mask:0x5
    s_nop 1
    v_add_f32_dpp v127, v49, v49 row_shr:4 row_mask:0xf bank_mask:0xa
    s_nop 1
    v_add_f32_dpp v127, v127, v127 quad_perm:[1,0,3,2] row_mask:0xf bank_mask:0xf
    s_nop 1
    v_add_f32_dpp v127, v127, v127 quad_perm:[2,3,0,1] row_mask:0xf bank_mask:0xf
    v_cvt_pk_bf16_f32 v48, v126, v127
    v_lshlrev_b32 v126, 16, v48
    v_and_b32 v127, 0xffff0000, v48
    v_mul_f32 v126, 0x3db504f3, v126
    v_mul_f32 v127, 0x3db504f3, v127
    v_cvt_pk_bf16_f32 v48, v126, v127
    v_lshlrev_b32 v126, 16, v48
    v_and_b32 v127, 0xffff0000, v48
    v_max3_f32 v14, v126, v127, v14
    s_add_u32 s10, s10, 10240
    buffer_load_dwordx4 a[120:123], v18, s[40:43], s10 offen offset:0
    buffer_load_dwordx4 a[124:127], v18, s[40:43], s10 offen offset:256
    v_max_f32_dpp v14, v14, v14 row_ror:8 row_mask:0xf bank_mask:0xf
    s_nop 1
    v_max_f32_dpp v14, v14, v14 row_ror:4 row_mask:0xf bank_mask:0xf
    s_nop 1
    v_max_f32_dpp v14, v14, v14 row_ror:2 row_mask:0xf bank_mask:0xf
    s_nop 1
    v_max_f32_dpp v14, v14, v14 row_ror:1 row_mask:0xf bank_mask:0xf
    s_nop 1
    v_max_f32_dpp v14, v14, v14 row_bcast:15 row_mask:0xa bank_mask:0xf
    s_nop 1
    v_max_f32_dpp v14, v14, v14 row_bcast:31 row_mask:0xc bank_mask:0xf
    s_nop 0
    v_readlane_b32 s76, v14, 63
    s_nop 1
    v_mov_b32 v14, s76
    v_mul_f32 v14, s85, v14
    s_nop 0
    v_readfirstlane_b32 s84, v14
    v_sub_f32 v14, 0, v14
    v_mov_b32 v15, 0
    v_fma_f32 v96, v96, s85, v14
    v_fma_f32 v97, v97, s85, v14
    v_fma_f32 v98, v98, s85, v14
    v_fma_f32 v99, v99, s85, v14
    v_fma_f32 v100, v100, s85, v14
    v_fma_f32 v101, v101, s85, v14
    v_fma_f32 v102, v102, s85, v14
    v_fma_f32 v103, v103, s85, v14
    v_exp_f32 v96, v96
    v_exp_f32 v97, v97
    v_exp_f32 v98, v98
    v_exp_f32 v99, v99
    v_exp_f32 v100, v100
    v_exp_f32 v101, v101
    v_exp_f32 v102, v102
    v_exp_f32 v103, v103
    v_add_f32 v15, v15, v96
    v_and_b32 v48, v96, v9
    v_sub_f32 v48, v96, v48
    v_perm_b32 v96, v48, v48, v10
    v_add_f32 v15, v15, v97
    v_and_b32 v49, v97, v9
    v_sub_f32 v49, v97, v49
    v_perm_b32 v97, v49, v49, v10
    v_add_f32 v15, v15, v98
    v_and_b32 v50, v98, v9
    v_sub_f32 v50, v98, v50
    v_perm_b32 v98, v50, v50, v10
    v_add_f32 v15, v15, v99
    v_and_b32 v51, v99, v9
    v_sub_f32 v51, v99, v51
    v_perm_b32 v99, v51, v51, v10
    v_add_f32 v15, v15, v100
    v_and_b32 v48, v100, v9
    v_sub_f32 v48, v100, v48
    v_perm_b32 v100, v48, v48, v10
    v_add_f32 v15, v15, v101
    v_and_b32 v49, v101, v9
    v_sub_f32 v49, v101, v49
    v_perm_b32 v101, v49, v49, v10
    v_add_f32 v15, v15, v102
    v_and_b32 v50, v102, v9
    v_sub_f32 v50, v102, v50
    v_perm_b32 v102, v50, v50, v10
    v_add_f32 v15, v15, v103
    v_and_b32 v51, v103, v9
    v_sub_f32 v51, v103, v51
    v_perm_b32 v103, v51, v51, v10
    v_mov_b32_dpp v80, v96 quad_perm:[0,1,2,3] row_mask:0xf bank_mask:0x1
    v_mov_b32_dpp v81, v96 row_shr:4 row_mask:0xf bank_mask:0x2
    v_mov_b32_dpp v82, v96 row_shr:8 row_mask:0xf bank_mask:0x4
    v_mov_b32_dpp v83, v96 row_shr:12 row_mask:0xf bank_mask:0x8
    s_waitcnt vmcnt(12)
    v_mov_b32_dpp v84, v96 row_shl:4 row_mask:0xf bank_mask:0x1
    v_mov_b32_dpp v85, v96 quad_perm:[0,1,2,3] row_mask:0xf bank_mask:0x2
    v_mov_b32_dpp v86, v96 row_shr:4 row_mask:0xf bank_mask:0x4
    v_mov_b32_dpp v87, v96 row_shr:8 row_mask:0xf bank_mask:0x8
    v_mfma_f32_16x16x32_bf16 v[44:47], v[80:83], v[128:131], 0
    s_add_u32 s82, s82, 0x1000
    buffer_load_dwordx4 v[156:159], v4, s[32:35], s82 offen nt
    s_waitcnt vmcnt(10)
    v_mov_b32_dpp v80, v96 row_shl:8 row_mask:0xf bank_mask:0x1
    v_mov_b32_dpp v81, v96 row_shl:4 row_mask:0xf bank_mask:0x2
    v_mov_b32_dpp v82, v96 quad_perm:[0,1,2,3] row_mask:0xf bank_mask:0x4
    v_mov_b32_dpp v83, v96 row_shr:4 row_mask:0xf bank_mask:0x8
    v_mfma_f32_16x16x32_bf16 v[44:47], v[84:87], v[132:135], v[44:47]
    s_add_u32 s82, s82, 0x1000
    buffer_load_dwordx4 v[160:163], v4, s[32:35], s82 offen nt
    s_waitcnt vmcnt(10)
    v_mov_b32_dpp v84, v96 row_shl:12 row_mask:0xf bank_mask:0x1
    v_mov_b32_dpp v85, v96 row_shl:8 row_mask:0xf bank_mask:0x2
    v_mov_b32_dpp v86, v96 row_shl:4 row_mask:0xf bank_mask:0x4
    v_mov_b32_dpp v87, v96 quad_perm:[0,1,2,3] row_mask:0xf bank_mask:0x8
    v_mfma_f32_16x16x32_bf16 v[44:47], v[80:83], v[136:139], v[44:47]
    s_add_u32 s82, s82, 0x1000
    buffer_load_dwordx4 v[164:167], v4, s[32:35], s82 offen nt
    s_waitcnt vmcnt(10)
    v_mov_b32_dpp v80, v97 quad_perm:[0,1,2,3] row_mask:0xf bank_mask:0x1
    v_mov_b32_dpp v81, v97 row_shr:4 row_mask:0xf bank_mask:0x2
    v_mov_b32_dpp v82, v97 row_shr:8 row_mask:0xf bank_mask:0x4
    v_mov_b32_dpp v83, v97 row_shr:12 row_mask:0xf bank_mask:0x8
    v_mfma_f32_16x16x32_bf16 v[44:47], v[84:87], v[140:143], v[44:47]
    s_add_u32 s82, s82, 0x1000
    buffer_load_dwordx4 v[168:171], v4, s[32:35], s82 offen nt
    v_fma_f32 v104, v104, s85, v14
    v_fma_f32 v105, v105, s85, v14
    v_fma_f32 v106, v106, s85, v14
    v_fma_f32 v107, v107, s85, v14
    v_fma_f32 v108, v108, s85, v14
    v_fma_f32 v109, v109, s85, v14
    v_fma_f32 v110, v110, s85, v14
    v_fma_f32 v111, v111, s85, v14
    v_exp_f32 v104, v104
    v_exp_f32 v105, v105
    v_exp_f32 v106, v106
    v_exp_f32 v107, v107
    v_exp_f32 v108, v108
    v_exp_f32 v109, v109
    v_exp_f32 v110, v110
    v_exp_f32 v111, v111
    v_add_f32 v15, v15, v104
    v_and_b32 v48, v104, v9
    v_sub_f32 v48, v104, v48
    v_perm_b32 v104, v48, v48, v10
    v_add_f32 v15, v15, v105
    v_and_b32 v49, v105, v9
    v_sub_f32 v49, v105, v49
    v_perm_b32 v105, v49, v49, v10
    v_add_f32 v15, v15, v106
    v_and_b32 v50, v106, v9
    v_sub_f32 v50, v106, v50
    v_perm_b32 v106, v50, v50, v10
    v_add_f32 v15, v15, v107
    v_and_b32 v51, v107, v9
    v_sub_f32 v51, v107, v51
    v_perm_b32 v107, v51, v51, v10
    v_add_f32 v15, v15, v108
    v_and_b32 v48, v108, v9
    v_sub_f32 v48, v108, v48
    v_perm_b32 v108, v48, v48, v10
    v_add_f32 v15, v15, v109
    v_and_b32 v49, v109, v9
    v_sub_f32 v49, v109, v49
    v_perm_b32 v109, v49, v49, v10
    v_add_f32 v15, v15, v110
    v_and_b32 v50, v110, v9
    v_sub_f32 v50, v110, v50
    v_perm_b32 v110, v50, v50, v10
    v_add_f32 v15, v15, v111
    v_and_b32 v51, v111, v9
    v_sub_f32 v51, v111, v51
    v_perm_b32 v111, v51, v51, v10
    buffer_load_dwordx4 a[128:131], v18, s[40:43], s10 offen offset:512
    buffer_load_dwordx4 a[132:135], v18, s[40:43], s10 offen offset:768
    s_waitcnt vmcnt(12)
    v_mov_b32_dpp v84, v97 row_shl:4 row_mask:0xf bank_mask:0x1
    v_mov_b32_dpp v85, v97 quad_perm:[0,1,2,3] row_mask:0xf bank_mask:0x2
    v_mov_b32_dpp v86, v97 row_shr:4 row_mask:0xf bank_mask:0x4
    v_mov_b32_dpp v87, v97 row_shr:8 row_mask:0xf bank_mask:0x8
    v_mfma_f32_16x16x32_bf16 v[44:47], v[80:83], v[144:147], v[44:47]
    s_add_u32 s82, s82, 0x1000
    buffer_load_dwordx4 v[172:175], v4, s[32:35], s82 offen nt
    s_waitcnt vmcnt(10)
    v_mov_b32_dpp v80, v97 row_shl:8 row_mask:0xf bank_mask:0x1
    v_mov_b32_dpp v81, v97 row_shl:4 row_mask:0xf bank_mask:0x2
    v_mov_b32_dpp v82, v97 quad_perm:[0,1,2,3] row_mask:0xf bank_mask:0x4
    v_mov_b32_dpp v83, v97 row_shr:4 row_mask:0xf bank_mask:0x8
    v_mfma_f32_16x16x32_bf16 v[44:47], v[84:87], v[148:151], v[44:47]
    s_add_u32 s82, s82, 0x1000
    buffer_load_dwordx4 v[176:179], v4, s[32:35], s82 offen nt
    s_waitcnt vmcnt(10)
    v_mov_b32_dpp v84, v97 row_shl:12 row_mask:0xf bank_mask:0x1
    v_mov_b32_dpp v85, v97 row_shl:8 row_mask:0xf bank_mask:0x2
    v_mov_b32_dpp v86, v97 row_shl:4 row_mask:0xf bank_mask:0x4
    v_mov_b32_dpp v87, v97 quad_perm:[0,1,2,3] row_mask:0xf bank_mask:0x8
    v_mfma_f32_16x16x32_bf16 v[44:47], v[80:83], v[152:155], v[44:47]
    s_add_u32 s82, s82, 0x1000
    buffer_load_dwordx4 v[180:183], v4, s[32:35], s82 offen nt
    s_waitcnt vmcnt(8)
    v_mov_b32_dpp v80, v98 quad_perm:[0,1,2,3] row_mask:0xf bank_mask:0x1
    v_mov_b32_dpp v81, v98 row_shr:4 row_mask:0xf bank_mask:0x2
    v_mov_b32_dpp v82, v98 row_shr:8 row_mask:0xf bank_mask:0x4
    v_mov_b32_dpp v83, v98 row_shr:12 row_mask:0xf bank_mask:0x8
    v_mfma_f32_16x16x32_bf16 v[44:47], v[84:87], v[156:159], v[44:47]
    s_add_u32 s82, s82, 0x1000
    buffer_load_dwordx4 v[184:187], v4, s[32:35], s82 offen nt
    v_fma_f32 v112, v112, s85, v14
    v_fma_f32 v113, v113, s85, v14
    v_fma_f32 v114, v114, s85, v14
    v_fma_f32 v115, v115, s85, v14
    v_fma_f32 v116, v116, s85, v14
    v_fma_f32 v117, v117, s85, v14
    v_fma_f32 v118, v118, s85, v14
    v_fma_f32 v119, v119, s85, v14
    v_exp_f32 v112, v112
    v_exp_f32 v113, v113
    v_exp_f32 v114, v114
    v_exp_f32 v115, v115
    v_exp_f32 v116, v116
    v_exp_f32 v117, v117
    v_exp_f32 v118, v118
    v_exp_f32 v119, v119
    v_add_f32 v15, v15, v112
    v_and_b32 v48, v112, v9
    v_sub_f32 v48, v112, v48
    v_perm_b32 v112, v48, v48, v10
    v_add_f32 v15, v15, v113
    v_and_b32 v49, v113, v9
    v_sub_f32 v49, v113, v49
    v_perm_b32 v113, v49, v49, v10
    v_add_f32 v15, v15, v114
    v_and_b32 v50, v114, v9
    v_sub_f32 v50, v114, v50
    v_perm_b32 v114, v50, v50, v10
    v_add_f32 v15, v15, v115
    v_and_b32 v51, v115, v9
    v_sub_f32 v51, v115, v51
    v_perm_b32 v115, v51, v51, v10
    v_add_f32 v15, v15, v116
    v_and_b32 v48, v116, v9
    v_sub_f32 v48, v116, v48
    v_perm_b32 v116, v48, v48, v10
    v_add_f32 v15, v15, v117
    v_and_b32 v49, v117, v9
    v_sub_f32 v49, v117, v49
    v_perm_b32 v117, v49, v49, v10
    v_add_f32 v15, v15, v118
    v_and_b32 v50, v118, v9
    v_sub_f32 v50, v118, v50
    v_perm_b32 v118, v50, v50, v10
    v_add_f32 v15, v15, v119
    v_and_b32 v51, v119, v9
    v_sub_f32 v51, v119, v51
    v_perm_b32 v119, v51, v51, v10
    buffer_load_dwordx4 a[136:139], v18, s[40:43], s10 offen offset:1024
    buffer_load_dwordx4 a[140:143], v18, s[40:43], s10 offen offset:1280
    s_waitcnt vmcnt(10)
    v_mov_b32_dpp v84, v98 row_shl:4 row_mask:0xf bank_mask:0x1
    v_mov_b32_dpp v85, v98 quad_perm:[0,1,2,3] row_mask:0xf bank_mask:0x2
    v_mov_b32_dpp v86, v98 row_shr:4 row_mask:0xf bank_mask:0x4
    v_mov_b32_dpp v87, v98 row_shr:8 row_mask:0xf bank_mask:0x8
    v_mfma_f32_16x16x32_bf16 v[44:47], v[80:83], v[160:163], v[44:47]
    s_add_u32 s82, s82, 0x1000
    buffer_load_dwordx4 v[188:191], v4, s[32:35], s82 offen nt
    s_waitcnt vmcnt(10)
    v_mov_b32_dpp v80, v98 row_shl:8 row_mask:0xf bank_mask:0x1
    v_mov_b32_dpp v81, v98 row_shl:4 row_mask:0xf bank_mask:0x2
    v_mov_b32_dpp v82, v98 quad_perm:[0,1,2,3] row_mask:0xf bank_mask:0x4
    v_mov_b32_dpp v83, v98 row_shr:4 row_mask:0xf bank_mask:0x8
    v_mfma_f32_16x16x32_bf16 v[44:47], v[84:87], v[164:167], v[44:47]
    s_add_u32 s82, s82, 0x1000
    buffer_load_dwordx4 v[192:195], v4, s[32:35], s82 offen nt
    s_waitcnt vmcnt(10)
    v_mov_b32_dpp v84, v98 row_shl:12 row_mask:0xf bank_mask:0x1
    v_mov_b32_dpp v85, v98 row_shl:8 row_mask:0xf bank_mask:0x2
    v_mov_b32_dpp v86, v98 row_shl:4 row_mask:0xf bank_mask:0x4
    v_mov_b32_dpp v87, v98 quad_perm:[0,1,2,3] row_mask:0xf bank_mask:0x8
    v_mfma_f32_16x16x32_bf16 v[44:47], v[80:83], v[168:171], v[44:47]
    s_add_u32 s82, s82, 0x1000
    buffer_load_dwordx4 v[196:199], v4, s[32:35], s82 offen nt
    s_waitcnt vmcnt(8)
    v_mov_b32_dpp v80, v99 quad_perm:[0,1,2,3] row_mask:0xf bank_mask:0x1
    v_mov_b32_dpp v81, v99 row_shr:4 row_mask:0xf bank_mask:0x2
    v_mov_b32_dpp v82, v99 row_shr:8 row_mask:0xf bank_mask:0x4
    v_mov_b32_dpp v83, v99 row_shr:12 row_mask:0xf bank_mask:0x8
    v_mfma_f32_16x16x32_bf16 v[44:47], v[84:87], v[172:175], v[44:47]
    s_add_u32 s82, s82, 0x1000
    buffer_load_dwordx4 v[200:203], v4, s[32:35], s82 offen nt
    v_fma_f32 v120, v120, s85, v14
    v_fma_f32 v121, v121, s85, v14
    v_fma_f32 v122, v122, s85, v14
    v_fma_f32 v123, v123, s85, v14
    v_fma_f32 v124, v124, s85, v14
    v_fma_f32 v125, v125, s85, v14
    v_fma_f32 v126, v126, s85, v14
    v_fma_f32 v127, v127, s85, v14
    v_exp_f32 v120, v120
    v_exp_f32 v121, v121
    v_exp_f32 v122, v122
    v_exp_f32 v123, v123
    v_exp_f32 v124, v124
    v_exp_f32 v125, v125
    v_exp_f32 v126, v126
    v_exp_f32 v127, v127
    v_add_f32 v15, v15, v120
    v_and_b32 v48, v120, v9
    v_sub_f32 v48, v120, v48
    v_perm_b32 v120, v48, v48, v10
    v_add_f32 v15, v15, v121
    v_and_b32 v49, v121, v9
    v_sub_f32 v49, v121, v49
    v_perm_b32 v121, v49, v49, v10
    v_add_f32 v15, v15, v122
    v_and_b32 v50, v122, v9
    v_sub_f32 v50, v122, v50
    v_perm_b32 v122, v50, v50, v10
    v_add_f32 v15, v15, v123
    v_and_b32 v51, v123, v9
    v_sub_f32 v51, v123, v51
    v_perm_b32 v123, v51, v51, v10
    v_add_f32 v15, v15, v124
    v_and_b32 v48, v124, v9
    v_sub_f32 v48, v124, v48
    v_perm_b32 v124, v48, v48, v10
    v_add_f32 v15, v15, v125
    v_and_b32 v49, v125, v9
    v_sub_f32 v49, v125, v49
    v_perm_b32 v125, v49, v49, v10
    v_add_f32 v15, v15, v126
    v_and_b32 v50, v126, v9
    v_sub_f32 v50, v126, v50
    v_perm_b32 v126, v50, v50, v10
    v_add_f32 v15, v15, v127
    v_and_b32 v51, v127, v9
    v_sub_f32 v51, v127, v51
    v_perm_b32 v127, v51, v51, v10
    buffer_load_dwordx4 a[144:147], v18, s[40:43], s10 offen offset:1536
    buffer_load_dwordx4 a[148:151], v18, s[40:43], s10 offen offset:1792
    s_waitcnt vmcnt(10)
    v_mov_b32_dpp v84, v99 row_shl:4 row_mask:0xf bank_mask:0x1
    v_mov_b32_dpp v85, v99 quad_perm:[0,1,2,3] row_mask:0xf bank_mask:0x2
    v_mov_b32_dpp v86, v99 row_shr:4 row_mask:0xf bank_mask:0x4
    v_mov_b32_dpp v87, v99 row_shr:8 row_mask:0xf bank_mask:0x8
    v_mfma_f32_16x16x32_bf16 v[44:47], v[80:83], v[176:179], v[44:47]
    s_add_u32 s82, s82, 0x1000
    buffer_load_dwordx4 v[204:207], v4, s[32:35], s82 offen nt
    s_waitcnt vmcnt(10)
    v_mov_b32_dpp v80, v99 row_shl:8 row_mask:0xf bank_mask:0x1
    v_mov_b32_dpp v81, v99 row_shl:4 row_mask:0xf bank_mask:0x2
    v_mov_b32_dpp v82, v99 quad_perm:[0,1,2,3] row_mask:0xf bank_mask:0x4
    v_mov_b32_dpp v83, v99 row_shr:4 row_mask:0xf bank_mask:0x8
    v_mfma_f32_16x16x32_bf16 v[44:47], v[84:87], v[180:183], v[44:47]
    s_add_u32 s82, s82, 0x1000
    buffer_load_dwordx4 v[208:211], v4, s[32:35], s82 offen nt
    s_waitcnt vmcnt(10)
    v_mov_b32_dpp v84, v99 row_shl:12 row_mask:0xf bank_mask:0x1
    v_mov_b32_dpp v85, v99 row_shl:8 row_mask:0xf bank_mask:0x2
    v_mov_b32_dpp v86, v99 row_shl:4 row_mask:0xf bank_mask:0x4
    v_mov_b32_dpp v87, v99 quad_perm:[0,1,2,3] row_mask:0xf bank_mask:0x8
    v_mfma_f32_16x16x32_bf16 v[44:47], v[80:83], v[184:187], v[44:47]
    s_add_u32 s82, s82, 0x1000
    buffer_load_dwordx4 v[212:215], v4, s[32:35], s82 offen nt
    s_waitcnt vmcnt(8)
    v_mov_b32_dpp v80, v100 quad_perm:[0,1,2,3] row_mask:0xf bank_mask:0x1
    v_mov_b32_dpp v81, v100 row_shr:4 row_mask:0xf bank_mask:0x2
    v_mov_b32_dpp v82, v100 row_shr:8 row_mask:0xf bank_mask:0x4
    v_mov_b32_dpp v83, v100 row_shr:12 row_mask:0xf bank_mask:0x8
    v_mfma_f32_16x16x32_bf16 v[44:47], v[84:87], v[188:191], v[44:47]
    s_add_u32 s82, s82, 0x1000
    buffer_load_dwordx4 v[216:219], v4, s[32:35], s82 offen nt
    v_add_f32_dpp v15, v15, v15 row_ror:8 row_mask:0xf bank_mask:0xf
    s_nop 1
    v_add_f32_dpp v15, v15, v15 row_ror:4 row_mask:0xf bank_mask:0xf
    s_nop 1
    v_add_f32_dpp v15, v15, v15 row_ror:2 row_mask:0xf bank_mask:0xf
    s_nop 1
    v_add_f32_dpp v15, v15, v15 row_ror:1 row_mask:0xf bank_mask:0xf
    s_nop 1
    v_add_f32_dpp v15, v15, v15 row_bcast:15 row_mask:0xa bank_mask:0xf
    s_nop 1
    v_add_f32_dpp v15, v15, v15 row_bcast:31 row_mask:0xc bank_mask:0xf
    s_nop 0
    v_readlane_b32 s76, v15, 63
    v_mov_b32 v48, s84
    v_mov_b32 v49, 0.25
    v_mul_f32 v49, s76, v49
    v_mov_b32 v50, v22
    v_mov_b32 v51, v22
    buffer_store_dwordx4 v[48:51], v7, s[52:55], 0 offen sc1
    buffer_load_dwordx4 a[152:155], v18, s[40:43], s10 offen offset:2048
    buffer_load_dwordx4 a[156:159], v18, s[40:43], s10 offen offset:2304
    s_waitcnt vmcnt(11)
    v_mov_b32_dpp v84, v100 row_shl:4 row_mask:0xf bank_mask:0x1
    v_mov_b32_dpp v85, v100 quad_perm:[0,1,2,3] row_mask:0xf bank_mask:0x2
    v_mov_b32_dpp v86, v100 row_shr:4 row_mask:0xf bank_mask:0x4
    v_mov_b32_dpp v87, v100 row_shr:8 row_mask:0xf bank_mask:0x8
    v_mfma_f32_16x16x32_bf16 v[44:47], v[80:83], v[192:195], v[44:47]
    s_add_u32 s82, s82, 0x1000
    buffer_load_dwordx4 v[220:223], v4, s[32:35], s82 offen nt
    s_waitcnt vmcnt(11)
    v_mov_b32_dpp v80, v100 row_shl:8 row_mask:0xf bank_mask:0x1
    v_mov_b32_dpp v81, v100 row_shl:4 row_mask:0xf bank_mask:0x2
    v_mov_b32_dpp v82, v100 quad_perm:[0,1,2,3] row_mask:0xf bank_mask:0x4
    v_mov_b32_dpp v83, v100 row_shr:4 row_mask:0xf bank_mask:0x8
    v_mfma_f32_16x16x32_bf16 v[44:47], v[84:87], v[196:199], v[44:47]
    s_add_u32 s82, s82, 0x1000
    buffer_load_dwordx4 v[224:227], v4, s[32:35], s82 offen nt
    s_waitcnt vmcnt(11)
    v_mov_b32_dpp v84, v100 row_shl:12 row_mask:0xf bank_mask:0x1
    v_mov_b32_dpp v85, v100 row_shl:8 row_mask:0xf bank_mask:0x2
    v_mov_b32_dpp v86, v100 row_shl:4 row_mask:0xf bank_mask:0x4
    v_mov_b32_dpp v87, v100 quad_perm:[0,1,2,3] row_mask:0xf bank_mask:0x8
    v_mfma_f32_16x16x32_bf16 v[44:47], v[80:83], v[200:203], v[44:47]
    s_add_u32 s82, s82, 0x1000
    buffer_load_dwordx4 v[228:231], v4, s[32:35], s82 offen nt
    s_waitcnt vmcnt(9)
    v_mov_b32_dpp v80, v101 quad_perm:[0,1,2,3] row_mask:0xf bank_mask:0x1
    v_mov_b32_dpp v81, v101 row_shr:4 row_mask:0xf bank_mask:0x2
    v_mov_b32_dpp v82, v101 row_shr:8 row_mask:0xf bank_mask:0x4
    v_mov_b32_dpp v83, v101 row_shr:12 row_mask:0xf bank_mask:0x8
    v_mfma_f32_16x16x32_bf16 v[44:47], v[84:87], v[204:207], v[44:47]
    s_add_u32 s82, s82, 0x1000
    buffer_load_dwordx4 v[232:235], v4, s[32:35], s82 offen nt
    s_waitcnt vmcnt(9)
    v_mov_b32_dpp v84, v101 row_shl:4 row_mask:0xf bank_mask:0x1
    v_mov_b32_dpp v85, v101 quad_perm:[0,1,2,3] row_mask:0xf bank_mask:0x2
    v_mov_b32_dpp v86, v101 row_shr:4 row_mask:0xf bank_mask:0x4
    v_mov_b32_dpp v87, v101 row_shr:8 row_mask:0xf bank_mask:0x8
    v_mfma_f32_16x16x32_bf16 v[44:47], v[80:83], v[208:211], v[44:47]
    s_add_u32 s82, s82, 0x1000
    buffer_load_dwordx4 v[236:239], v4, s[32:35], s82 offen nt
    s_waitcnt vmcnt(9)
    v_mov_b32_dpp v80, v101 row_shl:8 row_mask:0xf bank_mask:0x1
    v_mov_b32_dpp v81, v101 row_shl:4 row_mask:0xf bank_mask:0x2
    v_mov_b32_dpp v82, v101 quad_perm:[0,1,2,3] row_mask:0xf bank_mask:0x4
    v_mov_b32_dpp v83, v101 row_shr:4 row_mask:0xf bank_mask:0x8
    v_mfma_f32_16x16x32_bf16 v[44:47], v[84:87], v[212:215], v[44:47]
    s_add_u32 s82, s82, 0x1000
    buffer_load_dwordx4 v[240:243], v4, s[32:35], s82 offen nt
    s_waitcnt vmcnt(9)
    v_mov_b32_dpp v84, v101 row_shl:12 row_mask:0xf bank_mask:0x1
    v_mov_b32_dpp v85, v101 row_shl:8 row_mask:0xf bank_mask:0x2
    v_mov_b32_dpp v86, v101 row_shl:4 row_mask:0xf bank_mask:0x4
    v_mov_b32_dpp v87, v101 quad_perm:[0,1,2,3] row_mask:0xf bank_mask:0x8
    v_mfma_f32_16x16x32_bf16 v[44:47], v[80:83], v[216:219], v[44:47]
    s_add_u32 s82, s82, 0x1000
    buffer_load_dwordx4 v[244:247], v4, s[32:35], s82 offen nt
    s_waitcnt vmcnt(6)
    v_mov_b32_dpp v80, v102 quad_perm:[0,1,2,3] row_mask:0xf bank_mask:0x1
    v_mov_b32_dpp v81, v102 row_shr:4 row_mask:0xf bank_mask:0x2
    v_mov_b32_dpp v82, v102 row_shr:8 row_mask:0xf bank_mask:0x4
    v_mov_b32_dpp v83, v102 row_shr:12 row_mask:0xf bank_mask:0x8
    v_mfma_f32_16x16x32_bf16 v[44:47], v[84:87], v[220:223], v[44:47]
    s_add_u32 s82, s82, 0x1000
    buffer_load_dwordx4 v[248:251], v4, s[32:35], s82 offen nt
    s_cmp_lt_u32 s80, 27
    s_cselect_b32 s86, 20000, 0
    s_cmp_lt_u32 s72, 2
    s_cselect_b32 s86, s86, 0
    s_waitcnt vmcnt(63)
L_f:
    v_xor_b32 v26, v33, v22
    v_xor_b32 v27, v35, v22
    v_or_b32 v26, v26, v27
    v_cmp_ne_u32 vcc, 0, v26
    s_nop 3
    s_cbranch_vccz L_f_done
    s_sub_u32 s86, s86, 1
    s_cbranch_scc1 L_f_done
    buffer_load_dwordx4 v[32:35], v21, s[52:55], 0 offen sc1
    s_waitcnt vmcnt(0)
    s_branch L_f
L_f_done:
    v_add_f32_dpp v32, v32, v32 quad_perm:[1,0,3,2] row_mask:0xf bank_mask:0xf
    v_add_f32_dpp v34, v34, v34 quad_perm:[1,0,3,2] row_mask:0xf bank_mask:0xf
    s_nop 0
    v_add_f32_dpp v32, v32, v32 quad_perm:[2,3,0,1] row_mask:0xf bank_mask:0xf
    v_add_f32_dpp v34, v34, v34 quad_perm:[2,3,0,1] row_mask:0xf bank_mask:0xf
    s_nop 0
    v_add_f32_dpp v32, v32, v32 row_half_mirror row_mask:0xf bank_mask:0xf
    v_add_f32_dpp v34, v34, v34 row_half_mirror row_mask:0xf bank_mask:0xf
    v_cvt_pk_bf16_f32 v26, v32, v34
    v_mov_b32 v27, v26
    s_nop 1
    v_mov_b32_dpp v27, v26 row_ror:8 row_mask:0xf bank_mask:0x3
    v_mov_b32_dpp v26, v26 row_ror:8 row_mask:0xf bank_mask:0xc
    v_lshlrev_b32 v32, 16, v26
    v_and_b32 v33, 0xffff0000, v26
    v_lshlrev_b32 v34, 16, v27
    v_and_b32 v35, 0xffff0000, v27
    v_mul_f32 v36, 0xbfb8aa3b, v32
    v_mul_f32 v37, 0xbfb8aa3b, v33
    v_exp_f32 v36, v36
    v_exp_f32 v37, v37
    v_add_f32 v36, 1.0, v36
    v_add_f32 v37, 1.0, v37
    v_rcp_f32 v36, v36
    v_rcp_f32 v37, v37
    v_mul_f32 v36, v32, v36
    v_mul_f32 v37, v33, v37
    v_cvt_pk_bf16_f32 v36, v36, v36
    v_and_b32 v36, 0xffff0000, v36
    v_cvt_pk_bf16_f32 v37, v37, v37
    v_and_b32 v37, 0xffff0000, v37
    v_mul_f32 v36, v36, v34
    v_mul_f32 v37, v37, v35
    s_bitcmp1_b32 s72, 0
    s_cselect_b64 vcc, -1, 0
    v_cndmask_b32 v36, v36, v37, vcc
    v_cvt_pk_bf16_f32 v36, v36, v36
    v_and_b32 v36, 0xffff0000, v36
    v_and_b32 v76, v36, v9
    v_sub_f32 v36, v36, v76
    v_perm_b32 v76, v36, v36, v52
    v_perm_b32 v77, v36, v36, v53
    v_perm_b32 v78, v36, v36, v54
    v_perm_b32 v79, v36, v36, v55
    s_waitcnt vmcnt(6)
    v_mov_b32_dpp v84, v102 row_shl:4 row_mask:0xf bank_mask:0x1
    v_mov_b32_dpp v85, v102 quad_perm:[0,1,2,3] row_mask:0xf bank_mask:0x2
    v_mov_b32_dpp v86, v102 row_shr:4 row_mask:0xf bank_mask:0x4
    v_mov_b32_dpp v87, v102 row_shr:8 row_mask:0xf bank_mask:0x8
    v_mfma_f32_16x16x32_bf16 v[44:47], v[80:83], v[224:227], v[44:47]
    s_add_u32 s82, s82, 0x1000
    buffer_load_dwordx4 v[252:255], v4, s[32:35], s82 offen nt
    s_waitcnt vmcnt(6)
    v_mov_b32_dpp v80, v102 row_shl:8 row_mask:0xf bank_mask:0x1
    v_mov_b32_dpp v81, v102 row_shl:4 row_mask:0xf bank_mask:0x2
    v_mov_b32_dpp v82, v102 quad_perm:[0,1,2,3] row_mask:0xf bank_mask:0x4
    v_mov_b32_dpp v83, v102 row_shr:4 row_mask:0xf bank_mask:0x8
    v_mfma_f32_16x16x32_bf16 v[44:47], v[84:87], v[228:231], v[44:47]
    s_add_u32 s82, s82, 0x1000
    s_and_b32 s82, s82, 0x7ffff
    buffer_load_dwordx4 v[128:131], v4, s[32:35], s82 offen nt
    s_waitcnt vmcnt(6)
    v_mov_b32_dpp v84, v102 row_shl:12 row_mask:0xf bank_mask:0x1
    v_mov_b32_dpp v85, v102 row_shl:8 row_mask:0xf bank_mask:0x2
    v_mov_b32_dpp v86, v102 row_shl:4 row_mask:0xf bank_mask:0x4
    v_mov_b32_dpp v87, v102 quad_perm:[0,1,2,3] row_mask:0xf bank_mask:0x8
    v_mfma_f32_16x16x32_bf16 v[44:47], v[80:83], v[232:235], v[44:47]
    s_add_u32 s82, s82, 0x1000
    buffer_load_dwordx4 v[132:135], v4, s[32:35], s82 offen nt
    s_waitcnt vmcnt(6)
    v_mov_b32_dpp v80, v103 quad_perm:[0,1,2,3] row_mask:0xf bank_mask:0x1
    v_mov_b32_dpp v81, v103 row_shr:4 row_mask:0xf bank_mask:0x2
    v_mov_b32_dpp v82, v103 row_shr:8 row_mask:0xf bank_mask:0x4
    v_mov_b32_dpp v83, v103 row_shr:12 row_mask:0xf bank_mask:0x8
    v_mfma_f32_16x16x32_bf16 v[44:47], v[84:87], v[236:239], v[44:47]
    s_add_u32 s82, s82, 0x1000
    buffer_load_dwordx4 v[136:139], v4, s[32:35], s82 offen nt
    s_waitcnt vmcnt(6)
    v_mov_b32_dpp v84, v103 row_shl:4 row_mask:0xf bank_mask:0x1
    v_mov_b32_dpp v85, v103 quad_perm:[0,1,2,3] row_mask:0xf bank_mask:0x2
    v_mov_b32_dpp v86, v103 row_shr:4 row_mask:0xf bank_mask:0x4
    v_mov_b32_dpp v87, v103 row_shr:8 row_mask:0xf bank_mask:0x8
    v_mfma_f32_16x16x32_bf16 v[44:47], v[80:83], v[240:243], v[44:47]
    s_add_u32 s82, s82, 0x1000
    buffer_load_dwordx4 v[140:143], v4, s[32:35], s82 offen nt
    s_waitcnt vmcnt(6)
    v_mov_b32_dpp v80, v103 row_shl:8 row_mask:0xf bank_mask:0x1
    v_mov_b32_dpp v81, v103 row_shl:4 row_mask:0xf bank_mask:0x2
    v_mov_b32_dpp v82, v103 quad_perm:[0,1,2,3] row_mask:0xf bank_mask:0x4
    v_mov_b32_dpp v83, v103 row_shr:4 row_mask:0xf bank_mask:0x8
    v_mfma_f32_16x16x32_bf16 v[44:47], v[84:87], v[244:247], v[44:47]
    s_add_u32 s82, s82, 0x1000
    buffer_load_dwordx4 v[144:147], v4, s[32:35], s82 offen nt
    s_waitcnt vmcnt(6)
    v_mov_b32_dpp v84, v103 row_shl:12 row_mask:0xf bank_mask:0x1
    v_mov_b32_dpp v85, v103 row_shl:8 row_mask:0xf bank_mask:0x2
    v_mov_b32_dpp v86, v103 row_shl:4 row_mask:0xf bank_mask:0x4
    v_mov_b32_dpp v87, v103 quad_perm:[0,1,2,3] row_mask:0xf bank_mask:0x8
    v_mfma_f32_16x16x32_bf16 v[44:47], v[80:83], v[248:251], v[44:47]
    s_add_u32 s82, s82, 0x1000
    buffer_load_dwordx4 v[148:151], v4, s[32:35], s82 offen nt
    s_waitcnt vmcnt(6)
    v_mov_b32_dpp v80, v104 quad_perm:[0,1,2,3] row_mask:0xf bank_mask:0x1
    v_mov_b32_dpp v81, v104 row_shr:4 row_mask:0xf bank_mask:0x2
    v_mov_b32_dpp v82, v104 row_shr:8 row_mask:0xf bank_mask:0x4
    v_mov_b32_dpp v83, v104 row_shr:12 row_mask:0xf bank_mask:0x8
    v_mfma_f32_16x16x32_bf16 v[44:47], v[84:87], v[252:255], v[44:47]
    s_add_u32 s82, s82, 0x1000
    buffer_load_dwordx4 v[152:155], v4, s[32:35], s82 offen nt
    s_waitcnt vmcnt(6)
    v_mov_b32_dpp v84, v104 row_shl:4 row_mask:0xf bank_mask:0x1
    v_mov_b32_dpp v85, v104 quad_perm:[0,1,2,3] row_mask:0xf bank_mask:0x2
    v_mov_b32_dpp v86, v104 row_shr:4 row_mask:0xf bank_mask:0x4
    v_mov_b32_dpp v87, v104 row_shr:8 row_mask:0xf bank_mask:0x8
    v_mfma_f32_16x16x32_bf16 v[44:47], v[80:83], v[128:131], v[44:47]
    s_add_u32 s82, s82, 0x1000
    buffer_load_dwordx4 v[156:159], v4, s[32:35], s82 offen nt
    s_waitcnt vmcnt(6)
    v_mov_b32_dpp v80, v104 row_shl:8 row_mask:0xf bank_mask:0x1
    v_mov_b32_dpp v81, v104 row_shl:4 row_mask:0xf bank_mask:0x2
    v_mov_b32_dpp v82, v104 quad_perm:[0,1,2,3] row_mask:0xf bank_mask:0x4
    v_mov_b32_dpp v83, v104 row_shr:4 row_mask:0xf bank_mask:0x8
    v_mfma_f32_16x16x32_bf16 v[44:47], v[84:87], v[132:135], v[44:47]
    s_add_u32 s82, s82, 0x1000
    buffer_load_dwordx4 v[160:163], v4, s[32:35], s82 offen nt
    s_waitcnt vmcnt(6)
    v_mov_b32_dpp v84, v104 row_shl:12 row_mask:0xf bank_mask:0x1
    v_mov_b32_dpp v85, v104 row_shl:8 row_mask:0xf bank_mask:0x2
    v_mov_b32_dpp v86, v104 row_shl:4 row_mask:0xf bank_mask:0x4
    v_mov_b32_dpp v87, v104 quad_perm:[0,1,2,3] row_mask:0xf bank_mask:0x8
    v_mfma_f32_16x16x32_bf16 v[44:47], v[80:83], v[136:139], v[44:47]
    s_add_u32 s82, s82, 0x1000
    buffer_load_dwordx4 v[164:167], v4, s[32:35], s82 offen nt
    s_waitcnt vmcnt(6)
    v_mov_b32_dpp v80, v105 quad_perm:[0,1,2,3] row_mask:0xf bank_mask:0x1
    v_mov_b32_dpp v81, v105 row_shr:4 row_mask:0xf bank_mask:0x2
    v_mov_b32_dpp v82, v105 row_shr:8 row_mask:0xf bank_mask:0x4
    v_mov_b32_dpp v83, v105 row_shr:12 row_mask:0xf bank_mask:0x8
    v_mfma_f32_16x16x32_bf16 v[44:47], v[84:87], v[140:143], v[44:47]
    s_add_u32 s82, s82, 0x1000
    buffer_load_dwordx4 v[168:171], v4, s[32:35], s82 offen nt
    s_waitcnt vmcnt(6)
    v_mov_b32_dpp v84, v105 row_shl:4 row_mask:0xf bank_mask:0x1
    v_mov_b32_dpp v85, v105 quad_perm:[0,1,2,3] row_mask:0xf bank_mask:0x2
    v_mov_b32_dpp v86, v105 row_shr:4 row_mask:0xf bank_mask:0x4
    v_mov_b32_dpp v87, v105 row_shr:8 row_mask:0xf bank_mask:0x8
    v_mfma_f32_16x16x32_bf16 v[44:47], v[80:83], v[144:147], v[44:47]
    s_add_u32 s82, s82, 0x1000
    buffer_load_dwordx4 v[172:175], v4, s[32:35], s82 offen nt
    s_waitcnt vmcnt(6)
    v_mov_b32_dpp v80, v105 row_shl:8 row_mask:0xf bank_mask:0x1
    v_mov_b32_dpp v81, v105 row_shl:4 row_mask:0xf bank_mask:0x2
    v_mov_b32_dpp v82, v105 quad_perm:[0,1,2,3] row_mask:0xf bank_mask:0x4
    v_mov_b32_dpp v83, v105 row_shr:4 row_mask:0xf bank_mask:0x8
    v_mfma_f32_16x16x32_bf16 v[44:47], v[84:87], v[148:151], v[44:47]
    s_add_u32 s82, s82, 0x1000
    buffer_load_dwordx4 v[176:179], v4, s[32:35], s82 offen nt
    s_waitcnt vmcnt(6)
    v_mov_b32_dpp v84, v105 row_shl:12 row_mask:0xf bank_mask:0x1
    v_mov_b32_dpp v85, v105 row_shl:8 row_mask:0xf bank_mask:0x2
    v_mov_b32_dpp v86, v105 row_shl:4 row_mask:0xf bank_mask:0x4
    v_mov_b32_dpp v87, v105 quad_perm:[0,1,2,3] row_mask:0xf bank_mask:0x8
    v_mfma_f32_16x16x32_bf16 v[44:47], v[80:83], v[152:155], v[44:47]
    s_add_u32 s82, s82, 0x1000
    buffer_load_dwordx4 v[180:183], v4, s[32:35], s82 offen nt
    s_waitcnt vmcnt(6)
    v_mov_b32_dpp v80, v106 quad_perm:[0,1,2,3] row_mask:0xf bank_mask:0x1
    v_mov_b32_dpp v81, v106 row_shr:4 row_mask:0xf bank_mask:0x2
    v_mov_b32_dpp v82, v106 row_shr:8 row_mask:0xf bank_mask:0x4
    v_mov_b32_dpp v83, v106 row_shr:12 row_mask:0xf bank_mask:0x8
    v_mfma_f32_16x16x32_bf16 v[44:47], v[84:87], v[156:159], v[44:47]
    s_add_u32 s82, s82, 0x1000
    buffer_load_dwordx4 v[184:187], v4, s[32:35], s82 offen nt
    s_waitcnt vmcnt(6)
    v_mov_b32_dpp v84, v106 row_shl:4 row_mask:0xf bank_mask:0x1
    v_mov_b32_dpp v85, v106 quad_perm:[0,1,2,3] row_mask:0xf bank_mask:0x2
    v_mov_b32_dpp v86, v106 row_shr:4 row_mask:0xf bank_mask:0x4
    v_mov_b32_dpp v87, v106 row_shr:8 row_mask:0xf bank_mask:0x8
    v_mfma_f32_16x16x32_bf16 v[44:47], v[80:83], v[160:163], v[44:47]
    s_add_u32 s82, s82, 0x1000
    buffer_load_dwordx4 v[188:191], v4, s[32:35], s82 offen nt
    s_waitcnt vmcnt(6)
    v_mov_b32_dpp v80, v106 row_shl:8 row_mask:0xf bank_mask:0x1
    v_mov_b32_dpp v81, v106 row_shl:4 row_mask:0xf bank_mask:0x2
    v_mov_b32_dpp v82, v106 quad_perm:[0,1,2,3] row_mask:0xf bank_mask:0x4
    v_mov_b32_dpp v83, v106 row_shr:4 row_mask:0xf bank_mask:0x8
    v_mfma_f32_16x16x32_bf16 v[44:47], v[84:87], v[164:167], v[44:47]
    s_add_u32 s82, s82, 0x1000
    buffer_load_dwordx4 v[192:195], v4, s[32:35], s82 offen nt
    s_waitcnt vmcnt(6)
    v_mov_b32_dpp v84, v106 row_shl:12 row_mask:0xf bank_mask:0x1
    v_mov_b32_dpp v85, v106 row_shl:8 row_mask:0xf bank_mask:0x2
    v_mov_b32_dpp v86, v106 row_shl:4 row_mask:0xf bank_mask:0x4
    v_mov_b32_dpp v87, v106 quad_perm:[0,1,2,3] row_mask:0xf bank_mask:0x8
    v_mfma_f32_16x16x32_bf16 v[44:47], v[80:83], v[168:171], v[44:47]
    s_add_u32 s82, s82, 0x1000
    buffer_load_dwordx4 v[196:199], v4, s[32:35], s82 offen nt
    s_waitcnt vmcnt(6)
    v_mov_b32_dpp v80, v107 quad_perm:[0,1,2,3] row_mask:0xf bank_mask:0x1
    v_mov_b32_dpp v81, v107 row_shr:4 row_mask:0xf bank_mask:0x2
    v_mov_b32_dpp v82, v107 row_shr:8 row_mask:0xf bank_mask:0x4
    v_mov_b32_dpp v83, v107 row_shr:12 row_mask:0xf bank_mask:0x8
    v_mfma_f32_16x16x32_bf16 v[44:47], v[84:87], v[172:175], v[44:47]
    s_add_u32 s82, s82, 0x1000
    buffer_load_dwordx4 v[200:203], v4, s[32:35], s82 offen nt
    s_waitcnt vmcnt(6)
    v_mov_b32_dpp v84, v107 row_shl:4 row_mask:0xf bank_mask:0x1
    v_mov_b32_dpp v85, v107 quad_perm:[0,1,2,3] row_mask:0xf bank_mask:0x2
    v_mov_b32_dpp v86, v107 row_shr:4 row_mask:0xf bank_mask:0x4
    v_mov_b32_dpp v87, v107 row_shr:8 row_mask:0xf bank_mask:0x8
    v_mfma_f32_16x16x32_bf16 v[44:47], v[80:83], v[176:179], v[44:47]
    s_add_u32 s82, s82, 0x1000
    buffer_load_dwordx4 v[204:207], v4, s[32:35], s82 offen nt
    s_waitcnt vmcnt(6)
    v_mov_b32_dpp v80, v107 row_shl:8 row_mask:0xf bank_mask:0x1
    v_mov_b32_dpp v81, v107 row_shl:4 row_mask:0xf bank_mask:0x2
    v_mov_b32_dpp v82, v107 quad_perm:[0,1,2,3] row_mask:0xf bank_mask:0x4
    v_mov_b32_dpp v83, v107 row_shr:4 row_mask:0xf bank_mask:0x8
    v_mfma_f32_16x16x32_bf16 v[44:47], v[84:87], v[180:183], v[44:47]
    s_add_u32 s82, s82, 0x1000
    buffer_load_dwordx4 v[208:211], v4, s[32:35], s82 offen nt
    s_waitcnt vmcnt(6)
    v_mov_b32_dpp v84, v107 row_shl:12 row_mask:0xf bank_mask:0x1
    v_mov_b32_dpp v85, v107 row_shl:8 row_mask:0xf bank_mask:0x2
    v_mov_b32_dpp v86, v107 row_shl:4 row_mask:0xf bank_mask:0x4
    v_mov_b32_dpp v87, v107 quad_perm:[0,1,2,3] row_mask:0xf bank_mask:0x8
    v_mfma_f32_16x16x32_bf16 v[44:47], v[80:83], v[184:187], v[44:47]
    s_add_u32 s82, s82, 0x1000
    buffer_load_dwordx4 v[212:215], v4, s[32:35], s82 offen nt
    s_waitcnt vmcnt(6)
    v_mov_b32_dpp v80, v108 quad_perm:[0,1,2,3] row_mask:0xf bank_mask:0x1
    v_mov_b32_dpp v81, v108 row_shr:4 row_mask:0xf bank_mask:0x2
    v_mov_b32_dpp v82, v108 row_shr:8 row_mask:0xf bank_mask:0x4
    v_mov_b32_dpp v83, v108 row_shr:12 row_mask:0xf bank_mask:0x8
    v_mfma_f32_16x16x32_bf16 v[44:47], v[84:87], v[188:191], v[44:47]
    s_add_u32 s82, s82, 0x1000
    buffer_load_dwordx4 v[216:219], v4, s[32:35], s82 offen nt
    s_waitcnt vmcnt(6)
    v_mov_b32_dpp v84, v108 row_shl:4 row_mask:0xf bank_mask:0x1
    v_mov_b32_dpp v85, v108 quad_perm:[0,1,2,3] row_mask:0xf bank_mask:0x2
    v_mov_b32_dpp v86, v108 row_shr:4 row_mask:0xf bank_mask:0x4
    v_mov_b32_dpp v87, v108 row_shr:8 row_mask:0xf bank_mask:0x8
    v_mfma_f32_16x16x32_bf16 v[44:47], v[80:83], v[192:195], v[44:47]
    s_add_u32 s82, s82, 0x1000
    buffer_load_dwordx4 v[220:223], v4, s[32:35], s82 offen nt
    s_waitcnt vmcnt(6)
    v_mov_b32_dpp v80, v108 row_shl:8 row_mask:0xf bank_mask:0x1
    v_mov_b32_dpp v81, v108 row_shl:4 row_mask:0xf bank_mask:0x2
    v_mov_b32_dpp v82, v108 quad_perm:[0,1,2,3] row_mask:0xf bank_mask:0x4
    v_mov_b32_dpp v83, v108 row_shr:4 row_mask:0xf bank_mask:0x8
    v_mfma_f32_16x16x32_bf16 v[44:47], v[84:87], v[196:199], v[44:47]
    s_add_u32 s82, s82, 0x1000
    buffer_load_dwordx4 v[224:227], v4, s[32:35], s82 offen nt
    s_waitcnt vmcnt(6)
    v_mov_b32_dpp v84, v108 row_shl:12 row_mask:0xf bank_mask:0x1
    v_mov_b32_dpp v85, v108 row_shl:8 row_mask:0xf bank_mask:0x2
    v_mov_b32_dpp v86, v108 row_shl:4 row_mask:0xf bank_mask:0x4
    v_mov_b32_dpp v87, v108 quad_perm:[0,1,2,3] row_mask:0xf bank_mask:0x8
    v_mfma_f32_16x16x32_bf16 v[44:47], v[80:83], v[200:203], v[44:47]
    s_add_u32 s82, s82, 0x1000
    buffer_load_dwordx4 v[228:231], v4, s[32:35], s82 offen nt
    s_waitcnt vmcnt(6)
    v_mov_b32_dpp v80, v109 quad_perm:[0,1,2,3] row_mask:0xf bank_mask:0x1
    v_mov_b32_dpp v81, v109 row_shr:4 row_mask:0xf bank_mask:0x2
    v_mov_b32_dpp v82, v109 row_shr:8 row_mask:0xf bank_mask:0x4
    v_mov_b32_dpp v83, v109 row_shr:12 row_mask:0xf bank_mask:0x8
    v_mfma_f32_16x16x32_bf16 v[44:47], v[84:87], v[204:207], v[44:47]
    s_add_u32 s82, s82, 0x1000
    buffer_load_dwordx4 v[232:235], v4, s[32:35], s82 offen nt
    s_waitcnt vmcnt(6)
    v_mov_b32_dpp v84, v109 row_shl:4 row_mask:0xf bank_mask:0x1
    v_mov_b32_dpp v85, v109 quad_perm:[0,1,2,3] row_mask:0xf bank_mask:0x2
    v_mov_b32_dpp v86, v109 row_shr:4 row_mask:0xf bank_mask:0x4
    v_mov_b32_dpp v87, v109 row_shr:8 row_mask:0xf bank_mask:0x8
    v_mfma_f32_16x16x32_bf16 v[44:47], v[80:83], v[208:211], v[44:47]
    s_add_u32 s82, s82, 0x1000
    buffer_load_dwordx4 v[236:239], v4, s[32:35], s82 offen nt
    s_waitcnt vmcnt(6)
    v_mov_b32_dpp v80, v109 row_shl:8 row_mask:0xf bank_mask:0x1
    v_mov_b32_dpp v81, v109 row_shl:4 row_mask:0xf bank_mask:0x2
    v_mov_b32_dpp v82, v109 quad_perm:[0,1,2,3] row_mask:0xf bank_mask:0x4
    v_mov_b32_dpp v83, v109 row_shr:4 row_mask:0xf bank_mask:0x8
    v_mfma_f32_16x16x32_bf16 v[44:47], v[84:87], v[212:215], v[44:47]
    s_add_u32 s82, s82, 0x1000
    buffer_load_dwordx4 v[240:243], v4, s[32:35], s82 offen nt
    s_waitcnt vmcnt(6)
    v_mov_b32_dpp v84, v109 row_shl:12 row_mask:0xf bank_mask:0x1
    v_mov_b32_dpp v85, v109 row_shl:8 row_mask:0xf bank_mask:0x2
    v_mov_b32_dpp v86, v109 row_shl:4 row_mask:0xf bank_mask:0x4
    v_mov_b32_dpp v87, v109 quad_perm:[0,1,2,3] row_mask:0xf bank_mask:0x8
    v_mfma_f32_16x16x32_bf16 v[44:47], v[80:83], v[216:219], v[44:47]
    s_add_u32 s82, s82, 0x1000
    buffer_load_dwordx4 v[244:247], v4, s[32:35], s82 offen nt
    s_waitcnt vmcnt(6)
    v_mov_b32_dpp v80, v110 quad_perm:[0,1,2,3] row_mask:0xf bank_mask:0x1
    v_mov_b32_dpp v81, v110 row_shr:4 row_mask:0xf bank_mask:0x2
    v_mov_b32_dpp v82, v110 row_shr:8 row_mask:0xf bank_mask:0x4
    v_mov_b32_dpp v83, v110 row_shr:12 row_mask:0xf bank_mask:0x8
    v_mfma_f32_16x16x32_bf16 v[44:47], v[84:87], v[220:223], v[44:47]
    s_add_u32 s82, s82, 0x1000
    buffer_load_dwordx4 v[248:251], v4, s[32:35], s82 offen nt
    s_waitcnt vmcnt(6)
    v_mov_b32_dpp v84, v110 row_shl:4 row_mask:0xf bank_mask:0x1
    v_mov_b32_dpp v85, v110 quad_perm:[0,1,2,3] row_mask:0xf bank_mask:0x2
    v_mov_b32_dpp v86, v110 row_shr:4 row_mask:0xf bank_mask:0x4
    v_mov_b32_dpp v87, v110 row_shr:8 row_mask:0xf bank_mask:0x8
    v_mfma_f32_16x16x32_bf16 v[44:47], v[80:83], v[224:227], v[44:47]
    s_add_u32 s82, s82, 0x1000
    buffer_load_dwordx4 v[252:255], v4, s[32:35], s82 offen nt
    s_waitcnt vmcnt(6)
    v_mov_b32_dpp v80, v110 row_shl:8 row_mask:0xf bank_mask:0x1
    v_mov_b32_dpp v81, v110 row_shl:4 row_mask:0xf bank_mask:0x2
    v_mov_b32_dpp v82, v110 quad_perm:[0,1,2,3] row_mask:0xf bank_mask:0x4
    v_mov_b32_dpp v83, v110 row_shr:4 row_mask:0xf bank_mask:0x8
    v_mfma_f32_16x16x32_bf16 v[44:47], v[84:87], v[228:231], v[44:47]
    s_add_u32 s82, s82, 0x1000
    s_and_b32 s82, s82, 0x7ffff
    buffer_load_dwordx4 v[128:131], v4, s[32:35], s82 offen nt
    s_waitcnt vmcnt(6)
    v_mov_b32_dpp v84, v110 row_shl:12 row_mask:0xf bank_mask:0x1
    v_mov_b32_dpp v85, v110 row_shl:8 row_mask:0xf bank_mask:0x2
    v_mov_b32_dpp v86, v110 row_shl:4 row_mask:0xf bank_mask:0x4
    v_mov_b32_dpp v87, v110 quad_perm:[0,1,2,3] row_mask:0xf bank_mask:0x8
    v_mfma_f32_16x16x32_bf16 v[44:47], v[80:83], v[232:235], v[44:47]
    s_add_u32 s82, s82, 0x1000
    buffer_load_dwordx4 v[132:135], v4, s[32:35], s82 offen nt
    s_waitcnt vmcnt(6)
    v_mov_b32_dpp v80, v111 quad_perm:[0,1,2,3] row_mask:0xf bank_mask:0x1
    v_mov_b32_dpp v81, v111 row_shr:4 row_mask:0xf bank_mask:0x2
    v_mov_b32_dpp v82, v111 row_shr:8 row_mask:0xf bank_mask:0x4
    v_mov_b32_dpp v83, v111 row_shr:12 row_mask:0xf bank_mask:0x8
    v_mfma_f32_16x16x32_bf16 v[44:47], v[84:87], v[236:239], v[44:47]
    s_add_u32 s82, s82, 0x1000
    buffer_load_dwordx4 v[136:139], v4, s[32:35], s82 offen nt
    s_waitcnt vmcnt(6)
    v_mov_b32_dpp v84, v111 row_shl:4 row_mask:0xf bank_mask:0x1
    v_mov_b32_dpp v85, v111 quad_perm:[0,1,2,3] row_mask:0xf bank_mask:0x2
    v_mov_b32_dpp v86, v111 row_shr:4 row_mask:0xf bank_mask:0x4
    v_mov_b32_dpp v87, v111 row_shr:8 row_mask:0xf bank_mask:0x8
    v_mfma_f32_16x16x32_bf16 v[44:47], v[80:83], v[240:243], v[44:47]
    s_add_u32 s82, s82, 0x1000
    buffer_load_dwordx4 v[140:143], v4, s[32:35], s82 offen nt
    s_waitcnt vmcnt(6)
    v_mov_b32_dpp v80, v111 row_shl:8 row_mask:0xf bank_mask:0x1
    v_mov_b32_dpp v81, v111 row_shl:4 row_mask:0xf bank_mask:0x2
    v_mov_b32_dpp v82, v111 quad_perm:[0,1,2,3] row_mask:0xf bank_mask:0x4
    v_mov_b32_dpp v83, v111 row_shr:4 row_mask:0xf bank_mask:0x8
    v_mfma_f32_16x16x32_bf16 v[44:47], v[84:87], v[244:247], v[44:47]
    s_add_u32 s82, s82, 0x1000
    buffer_load_dwordx4 v[144:147], v4, s[32:35], s82 offen nt
    s_waitcnt vmcnt(6)
    v_mov_b32_dpp v84, v111 row_shl:12 row_mask:0xf bank_mask:0x1
    v_mov_b32_dpp v85, v111 row_shl:8 row_mask:0xf bank_mask:0x2
    v_mov_b32_dpp v86, v111 row_shl:4 row_mask:0xf bank_mask:0x4
    v_mov_b32_dpp v87, v111 quad_perm:[0,1,2,3] row_mask:0xf bank_mask:0x8
    v_mfma_f32_16x16x32_bf16 v[44:47], v[80:83], v[248:251], v[44:47]
    s_add_u32 s82, s82, 0x1000
    buffer_load_dwordx4 v[148:151], v4, s[32:35], s82 offen nt
    s_waitcnt vmcnt(6)
    v_mov_b32_dpp v80, v112 quad_perm:[0,1,2,3] row_mask:0xf bank_mask:0x1
    v_mov_b32_dpp v81, v112 row_shr:4 row_mask:0xf bank_mask:0x2
    v_mov_b32_dpp v82, v112 row_shr:8 row_mask:0xf bank_mask:0x4
    v_mov_b32_dpp v83, v112 row_shr:12 row_mask:0xf bank_mask:0x8
    v_mfma_f32_16x16x32_bf16 v[44:47], v[84:87], v[252:255], v[44:47]
    s_add_u32 s82, s82, 0x1000
    buffer_load_dwordx4 v[152:155], v4, s[32:35], s82 offen nt
    v_and_b32 v28, 31, v0
    v_lshlrev_b32 v28, 4, v28
    s_lshl_b32 s76, s73, 9
    s_add_u32 s76, s76, 655360
    v_add_u32 v28, s76, v28
    buffer_load_dwordx4 v[32:35], v28, s[52:55], 0 offen sc1
    s_waitcnt vmcnt(7)
    v_mov_b32_dpp v84, v112 row_shl:4 row_mask:0xf bank_mask:0x1
    v_mov_b32_dpp v85, v112 quad_perm:[0,1,2,3] row_mask:0xf bank_mask:0x2
    v_mov_b32_dpp v86, v112 row_shr:4 row_mask:0xf bank_mask:0x4
    v_mov_b32_dpp v87, v112 row_shr:8 row_mask:0xf bank_mask:0x8
    v_mfma_f32_16x16x32_bf16 v[44:47], v[80:83], v[128:131], v[44:47]
    s_add_u32 s82, s82, 0x1000
    buffer_load_dwordx4 v[156:159], v4, s[32:35], s82 offen nt
    s_waitcnt vmcnt(7)
    v_mov_b32_dpp v80, v112 row_shl:8 row_mask:0xf bank_mask:0x1
    v_mov_b32_dpp v81, v112 row_shl:4 row_mask:0xf bank_mask:0x2
    v_mov_b32_dpp v82, v112 quad_perm:[0,1,2,3] row_mask:0xf bank_mask:0x4
    v_mov_b32_dpp v83, v112 row_shr:4 row_mask:0xf bank_mask:0x8
    v_mfma_f32_16x16x32_bf16 v[44:47], v[84:87], v[132:135], v[44:47]
    s_add_u32 s82, s82, 0x1000
    buffer_load_dwordx4 v[160:163], v4, s[32:35], s82 offen nt
    s_waitcnt vmcnt(7)
    v_mov_b32_dpp v84, v112 row_shl:12 row_mask:0xf bank_mask:0x1
    v_mov_b32_dpp v85, v112 row_shl:8 row_mask:0xf bank_mask:0x2
    v_mov_b32_dpp v86, v112 row_shl:4 row_mask:0xf bank_mask:0x4
    v_mov_b32_dpp v87, v112 quad_perm:[0,1,2,3] row_mask:0xf bank_mask:0x8
    v_mfma_f32_16x16x32_bf16 v[44:47], v[80:83], v[136:139], v[44:47]
    s_add_u32 s82, s82, 0x1000
    buffer_load_dwordx4 v[164:167], v4, s[32:35], s82 offen nt
    s_waitcnt vmcnt(7)
    v_mov_b32_dpp v80, v113 quad_perm:[0,1,2,3] row_mask:0xf bank_mask:0x1
    v_mov_b32_dpp v81, v113 row_shr:4 row_mask:0xf bank_mask:0x2
    v_mov_b32_dpp v82, v113 row_shr:8 row_mask:0xf bank_mask:0x4
    v_mov_b32_dpp v83, v113 row_shr:12 row_mask:0xf bank_mask:0x8
    v_mfma_f32_16x16x32_bf16 v[44:47], v[84:87], v[140:143], v[44:47]
    s_add_u32 s82, s82, 0x1000
    buffer_load_dwordx4 v[168:171], v4, s[32:35], s82 offen nt
    s_waitcnt vmcnt(7)
    v_mov_b32_dpp v84, v113 row_shl:4 row_mask:0xf bank_mask:0x1
    v_mov_b32_dpp v85, v113 quad_perm:[0,1,2,3] row_mask:0xf bank_mask:0x2
    v_mov_b32_dpp v86, v113 row_shr:4 row_mask:0xf bank_mask:0x4
    v_mov_b32_dpp v87, v113 row_shr:8 row_mask:0xf bank_mask:0x8
    v_mfma_f32_16x16x32_bf16 v[44:47], v[80:83], v[144:147], v[44:47]
    s_add_u32 s82, s82, 0x1000
    buffer_load_dwordx4 v[172:175], v4, s[32:35], s82 offen nt
    s_waitcnt vmcnt(7)
    v_mov_b32_dpp v80, v113 row_shl:8 row_mask:0xf bank_mask:0x1
    v_mov_b32_dpp v81, v113 row_shl:4 row_mask:0xf bank_mask:0x2
    v_mov_b32_dpp v82, v113 quad_perm:[0,1,2,3] row_mask:0xf bank_mask:0x4
    v_mov_b32_dpp v83, v113 row_shr:4 row_mask:0xf bank_mask:0x8
    v_mfma_f32_16x16x32_bf16 v[44:47], v[84:87], v[148:151], v[44:47]
    s_add_u32 s82, s82, 0x1000
    buffer_load_dwordx4 v[176:179], v4, s[32:35], s82 offen nt
    s_waitcnt vmcnt(7)
    v_mov_b32_dpp v84, v113 row_shl:12 row_mask:0xf bank_mask:0x1
    v_mov_b32_dpp v85, v113 row_shl:8 row_mask:0xf bank_mask:0x2
    v_mov_b32_dpp v86, v113 row_shl:4 row_mask:0xf bank_mask:0x4
    v_mov_b32_dpp v87, v113 quad_perm:[0,1,2,3] row_mask:0xf bank_mask:0x8
    v_mfma_f32_16x16x32_bf16 v[44:47], v[80:83], v[152:155], v[44:47]
    s_add_u32 s82, s82, 0x1000
    buffer_load_dwordx4 v[180:183], v4, s[32:35], s82 offen nt
    s_waitcnt vmcnt(6)
    v_mov_b32_dpp v80, v114 quad_perm:[0,1,2,3] row_mask:0xf bank_mask:0x1
    v_mov_b32_dpp v81, v114 row_shr:4 row_mask:0xf bank_mask:0x2
    v_mov_b32_dpp v82, v114 row_shr:8 row_mask:0xf bank_mask:0x4
    v_mov_b32_dpp v83, v114 row_shr:12 row_mask:0xf bank_mask:0x8
    v_mfma_f32_16x16x32_bf16 v[44:47], v[84:87], v[156:159], v[44:47]
    s_add_u32 s82, s82, 0x1000
    buffer_load_dwordx4 v[184:187], v4, s[32:35], s82 offen nt
    s_waitcnt vmcnt(6)
    v_mov_b32_dpp v84, v114 row_shl:4 row_mask:0xf bank_mask:0x1
    v_mov_b32_dpp v85, v114 quad_perm:[0,1,2,3] row_mask:0xf bank_mask:0x2
    v_mov_b32_dpp v86, v114 row_shr:4 row_mask:0xf bank_mask:0x4
    v_mov_b32_dpp v87, v114 row_shr:8 row_mask:0xf bank_mask:0x8
    v_mfma_f32_16x16x32_bf16 v[44:47], v[80:83], v[160:163], v[44:47]
    s_add_u32 s82, s82, 0x1000
    buffer_load_dwordx4 v[188:191], v4, s[32:35], s82 offen nt
    s_waitcnt vmcnt(6)
    v_mov_b32_dpp v80, v114 row_shl:8 row_mask:0xf bank_mask:0x1
    v_mov_b32_dpp v81, v114 row_shl:4 row_mask:0xf bank_mask:0x2
    v_mov_b32_dpp v82, v114 quad_perm:[0,1,2,3] row_mask:0xf bank_mask:0x4
    v_mov_b32_dpp v83, v114 row_shr:4 row_mask:0xf bank_mask:0x8
    v_mfma_f32_16x16x32_bf16 v[44:47], v[84:87], v[164:167], v[44:47]
    s_add_u32 s82, s82, 0x1000
    buffer_load_dwordx4 v[192:195], v4, s[32:35], s82 offen nt
    s_waitcnt vmcnt(6)
    v_mov_b32_dpp v84, v114 row_shl:12 row_mask:0xf bank_mask:0x1
    v_mov_b32_dpp v85, v114 row_shl:8 row_mask:0xf bank_mask:0x2
    v_mov_b32_dpp v86, v114 row_shl:4 row_mask:0xf bank_mask:0x4
    v_mov_b32_dpp v87, v114 quad_perm:[0,1,2,3] row_mask:0xf bank_mask:0x8
    v_mfma_f32_16x16x32_bf16 v[44:47], v[80:83], v[168:171], v[44:47]
    s_add_u32 s82, s82, 0x1000
    buffer_load_dwordx4 v[196:199], v4, s[32:35], s82 offen nt
    s_waitcnt vmcnt(6)
    v_mov_b32_dpp v80, v115 quad_perm:[0,1,2,3] row_mask:0xf bank_mask:0x1
    v_mov_b32_dpp v81, v115 row_shr:4 row_mask:0xf bank_mask:0x2
    v_mov_b32_dpp v82, v115 row_shr:8 row_mask:0xf bank_mask:0x4
    v_mov_b32_dpp v83, v115 row_shr:12 row_mask:0xf bank_mask:0x8
    v_mfma_f32_16x16x32_bf16 v[44:47], v[84:87], v[172:175], v[44:47]
    s_add_u32 s82, s82, 0x1000
    buffer_load_dwordx4 v[200:203], v4, s[32:35], s82 offen nt
    s_waitcnt vmcnt(6)
    v_mov_b32_dpp v84, v115 row_shl:4 row_mask:0xf bank_mask:0x1
    v_mov_b32_dpp v85, v115 quad_perm:[0,1,2,3] row_mask:0xf bank_mask:0x2
    v_mov_b32_dpp v86, v115 row_shr:4 row_mask:0xf bank_mask:0x4
    v_mov_b32_dpp v87, v115 row_shr:8 row_mask:0xf bank_mask:0x8
    v_mfma_f32_16x16x32_bf16 v[44:47], v[80:83], v[176:179], v[44:47]
    s_add_u32 s82, s82, 0x1000
    buffer_load_dwordx4 v[204:207], v4, s[32:35], s82 offen nt
    s_waitcnt vmcnt(6)
    v_mov_b32_dpp v80, v115 row_shl:8 row_mask:0xf bank_mask:0x1
    v_mov_b32_dpp v81, v115 row_shl:4 row_mask:0xf bank_mask:0x2
    v_mov_b32_dpp v82, v115 quad_perm:[0,1,2,3] row_mask:0xf bank_mask:0x4
    v_mov_b32_dpp v83, v115 row_shr:4 row_mask:0xf bank_mask:0x8
    v_mfma_f32_16x16x32_bf16 v[44:47], v[84:87], v[180:183], v[44:47]
    s_add_u32 s82, s82, 0x1000
    buffer_load_dwordx4 v[208:211], v4, s[32:35], s82 offen nt
    s_waitcnt vmcnt(6)
    v_mov_b32_dpp v84, v115 row_shl:12 row_mask:0xf bank_mask:0x1
    v_mov_b32_dpp v85, v115 row_shl:8 row_mask:0xf bank_mask:0x2
    v_mov_b32_dpp v86, v115 row_shl:4 row_mask:0xf bank_mask:0x4
    v_mov_b32_dpp v87, v115 quad_perm:[0,1,2,3] row_mask:0xf bank_mask:0x8
    v_mfma_f32_16x16x32_bf16 v[44:47], v[80:83], v[184:187], v[44:47]
    s_add_u32 s82, s82, 0x1000
    buffer_load_dwordx4 v[212:215], v4, s[32:35], s82 offen nt
    s_waitcnt vmcnt(6)
    v_mov_b32_dpp v80, v116 quad_perm:[0,1,2,3] row_mask:0xf bank_mask:0x1
    v_mov_b32_dpp v81, v116 row_shr:4 row_mask:0xf bank_mask:0x2
    v_mov_b32_dpp v82, v116 row_shr:8 row_mask:0xf bank_mask:0x4
    v_mov_b32_dpp v83, v116 row_shr:12 row_mask:0xf bank_mask:0x8
    v_mfma_f32_16x16x32_bf16 v[44:47], v[84:87], v[188:191], v[44:47]
    s_add_u32 s82, s82, 0x1000
    buffer_load_dwordx4 v[216:219], v4, s[32:35], s82 offen nt
    s_waitcnt vmcnt(6)
    v_mov_b32_dpp v84, v116 row_shl:4 row_mask:0xf bank_mask:0x1
    v_mov_b32_dpp v85, v116 quad_perm:[0,1,2,3] row_mask:0xf bank_mask:0x2
    v_mov_b32_dpp v86, v116 row_shr:4 row_mask:0xf bank_mask:0x4
    v_mov_b32_dpp v87, v116 row_shr:8 row_mask:0xf bank_mask:0x8
    v_mfma_f32_16x16x32_bf16 v[44:47], v[80:83], v[192:195], v[44:47]
    s_add_u32 s82, s82, 0x1000
    buffer_load_dwordx4 v[220:223], v4, s[32:35], s82 offen nt
    s_waitcnt vmcnt(6)
    v_mov_b32_dpp v80, v116 row_shl:8 row_mask:0xf bank_mask:0x1
    v_mov_b32_dpp v81, v116 row_shl:4 row_mask:0xf bank_mask:0x2
    v_mov_b32_dpp v82, v116 quad_perm:[0,1,2,3] row_mask:0xf bank_mask:0x4
    v_mov_b32_dpp v83, v116 row_shr:4 row_mask:0xf bank_mask:0x8
    v_mfma_f32_16x16x32_bf16 v[44:47], v[84:87], v[196:199], v[44:47]
    s_add_u32 s82, s82, 0x1000
    buffer_load_dwordx4 v[224:227], v4, s[32:35], s82 offen nt
    s_waitcnt vmcnt(6)
    v_mov_b32_dpp v84, v116 row_shl:12 row_mask:0xf bank_mask:0x1
    v_mov_b32_dpp v85, v116 row_shl:8 row_mask:0xf bank_mask:0x2
    v_mov_b32_dpp v86, v116 row_shl:4 row_mask:0xf bank_mask:0x4
    v_mov_b32_dpp v87, v116 quad_perm:[0,1,2,3] row_mask:0xf bank_mask:0x8
    v_mfma_f32_16x16x32_bf16 v[44:47], v[80:83], v[200:203], v[44:47]
    s_add_u32 s82, s82, 0x1000
    buffer_load_dwordx4 v[228:231], v4, s[32:35], s82 offen nt
    s_waitcnt vmcnt(6)
    v_mov_b32_dpp v80, v117 quad_perm:[0,1,2,3] row_mask:0xf bank_mask:0x1
    v_mov_b32_dpp v81, v117 row_shr:4 row_mask:0xf bank_mask:0x2
    v_mov_b32_dpp v82, v117 row_shr:8 row_mask:0xf bank_mask:0x4
    v_mov_b32_dpp v83, v117 row_shr:12 row_mask:0xf bank_mask:0x8
    v_mfma_f32_16x16x32_bf16 v[44:47], v[84:87], v[204:207], v[44:47]
    s_add_u32 s82, s82, 0x1000
    buffer_load_dwordx4 v[232:235], v4, s[32:35], s82 offen nt
    s_waitcnt vmcnt(6)
    v_mov_b32_dpp v84, v117 row_shl:4 row_mask:0xf bank_mask:0x1
    v_mov_b32_dpp v85, v117 quad_perm:[0,1,2,3] row_mask:0xf bank_mask:0x2
    v_mov_b32_dpp v86, v117 row_shr:4 row_mask:0xf bank_mask:0x4
    v_mov_b32_dpp v87, v117 row_shr:8 row_mask:0xf bank_mask:0x8
    v_mfma_f32_16x16x32_bf16 v[44:47], v[80:83], v[208:211], v[44:47]
    s_add_u32 s82, s82, 0x1000
    buffer_load_dwordx4 v[236:239], v4, s[32:35], s82 offen nt
    s_waitcnt vmcnt(6)
    v_mov_b32_dpp v80, v117 row_shl:8 row_mask:0xf bank_mask:0x1
    v_mov_b32_dpp v81, v117 row_shl:4 row_mask:0xf bank_mask:0x2
    v_mov_b32_dpp v82, v117 quad_perm:[0,1,2,3] row_mask:0xf bank_mask:0x4
    v_mov_b32_dpp v83, v117 row_shr:4 row_mask:0xf bank_mask:0x8
    v_mfma_f32_16x16x32_bf16 v[44:47], v[84:87], v[212:215], v[44:47]
    s_add_u32 s82, s82, 0x1000
    buffer_load_dwordx4 v[240:243], v4, s[32:35], s82 offen nt
    s_waitcnt vmcnt(6)
    v_mov_b32_dpp v84, v117 row_shl:12 row_mask:0xf bank_mask:0x1
    v_mov_b32_dpp v85, v117 row_shl:8 row_mask:0xf bank_mask:0x2
    v_mov_b32_dpp v86, v117 row_shl:4 row_mask:0xf bank_mask:0x4
    v_mov_b32_dpp v87, v117 quad_perm:[0,1,2,3] row_mask:0xf bank_mask:0x8
    v_mfma_f32_16x16x32_bf16 v[44:47], v[80:83], v[216:219], v[44:47]
    s_add_u32 s82, s82, 0x1000
    buffer_load_dwordx4 v[244:247], v4, s[32:35], s82 offen nt
    s_waitcnt vmcnt(6)
    v_mov_b32_dpp v80, v118 quad_perm:[0,1,2,3] row_mask:0xf bank_mask:0x1
    v_mov_b32_dpp v81, v118 row_shr:4 row_mask:0xf bank_mask:0x2
    v_mov_b32_dpp v82, v118 row_shr:8 row_mask:0xf bank_mask:0x4
    v_mov_b32_dpp v83, v118 row_shr:12 row_mask:0xf bank_mask:0x8
    v_mfma_f32_16x16x32_bf16 v[44:47], v[84:87], v[220:223], v[44:47]
    s_add_u32 s82, s82, 0x1000
    buffer_load_dwordx4 v[248:251], v4, s[32:35], s82 offen nt
    s_waitcnt vmcnt(6)
    v_mov_b32_dpp v84, v118 row_shl:4 row_mask:0xf bank_mask:0x1
    v_mov_b32_dpp v85, v118 quad_perm:[0,1,2,3] row_mask:0xf bank_mask:0x2
    v_mov_b32_dpp v86, v118 row_shr:4 row_mask:0xf bank_mask:0x4
    v_mov_b32_dpp v87, v118 row_shr:8 row_mask:0xf bank_mask:0x8
    v_mfma_f32_16x16x32_bf16 v[44:47], v[80:83], v[224:227], v[44:47]
    s_add_u32 s82, s82, 0x1000
    buffer_load_dwordx4 v[252:255], v4, s[32:35], s82 offen nt
    s_waitcnt vmcnt(6)
    v_mov_b32_dpp v80, v118 row_shl:8 row_mask:0xf bank_mask:0x1
    v_mov_b32_dpp v81, v118 row_shl:4 row_mask:0xf bank_mask:0x2
    v_mov_b32_dpp v82, v118 quad_perm:[0,1,2,3] row_mask:0xf bank_mask:0x4
    v_mov_b32_dpp v83, v118 row_shr:4 row_mask:0xf bank_mask:0x8
    v_mfma_f32_16x16x32_bf16 v[44:47], v[84:87], v[228:231], v[44:47]
    s_add_u32 s82, s82, 0x1000
    s_and_b32 s82, s82, 0x7ffff
    buffer_load_dwordx4 v[128:131], v4, s[32:35], s82 offen nt
    s_waitcnt vmcnt(6)
    v_mov_b32_dpp v84, v118 row_shl:12 row_mask:0xf bank_mask:0x1
    v_mov_b32_dpp v85, v118 row_shl:8 row_mask:0xf bank_mask:0x2
    v_mov_b32_dpp v86, v118 row_shl:4 row_mask:0xf bank_mask:0x4
    v_mov_b32_dpp v87, v118 quad_perm:[0,1,2,3] row_mask:0xf bank_mask:0x8
    v_mfma_f32_16x16x32_bf16 v[44:47], v[80:83], v[232:235], v[44:47]
    s_add_u32 s82, s82, 0x1000
    buffer_load_dwordx4 v[132:135], v4, s[32:35], s82 offen nt
    s_waitcnt vmcnt(6)
    v_mov_b32_dpp v80, v119 quad_perm:[0,1,2,3] row_mask:0xf bank_mask:0x1
    v_mov_b32_dpp v81, v119 row_shr:4 row_mask:0xf bank_mask:0x2
    v_mov_b32_dpp v82, v119 row_shr:8 row_mask:0xf bank_mask:0x4
    v_mov_b32_dpp v83, v119 row_shr:12 row_mask:0xf bank_mask:0x8
    v_mfma_f32_16x16x32_bf16 v[44:47], v[84:87], v[236:239], v[44:47]
    s_add_u32 s82, s82, 0x1000
    buffer_load_dwordx4 v[136:139], v4, s[32:35], s82 offen nt
    s_waitcnt vmcnt(6)
    v_mov_b32_dpp v84, v119 row_shl:4 row_mask:0xf bank_mask:0x1
    v_mov_b32_dpp v85, v119 quad_perm:[0,1,2,3] row_mask:0xf bank_mask:0x2
    v_mov_b32_dpp v86, v119 row_shr:4 row_mask:0xf bank_mask:0x4
    v_mov_b32_dpp v87, v119 row_shr:8 row_mask:0xf bank_mask:0x8
    v_mfma_f32_16x16x32_bf16 v[44:47], v[80:83], v[240:243], v[44:47]
    s_add_u32 s82, s82, 0x1000
    buffer_load_dwordx4 v[140:143], v4, s[32:35], s82 offen nt
    s_waitcnt vmcnt(6)
    v_mov_b32_dpp v80, v119 row_shl:8 row_mask:0xf bank_mask:0x1
    v_mov_b32_dpp v81, v119 row_shl:4 row_mask:0xf bank_mask:0x2
    v_mov_b32_dpp v82, v119 quad_perm:[0,1,2,3] row_mask:0xf bank_mask:0x4
    v_mov_b32_dpp v83, v119 row_shr:4 row_mask:0xf bank_mask:0x8
    v_mfma_f32_16x16x32_bf16 v[44:47], v[84:87], v[244:247], v[44:47]
    s_add_u32 s82, s82, 0x1000
    buffer_load_dwordx4 v[144:147], v4, s[32:35], s82 offen nt
    s_waitcnt vmcnt(6)
    v_mov_b32_dpp v84, v119 row_shl:12 row_mask:0xf bank_mask:0x1
    v_mov_b32_dpp v85, v119 row_shl:8 row_mask:0xf bank_mask:0x2
    v_mov_b32_dpp v86, v119 row_shl:4 row_mask:0xf bank_mask:0x4
    v_mov_b32_dpp v87, v119 quad_perm:[0,1,2,3] row_mask:0xf bank_mask:0x8
    v_mfma_f32_16x16x32_bf16 v[44:47], v[80:83], v[248:251], v[44:47]
    s_add_u32 s82, s82, 0x1000
    buffer_load_dwordx4 v[148:151], v4, s[32:35], s82 offen nt
    s_waitcnt vmcnt(6)
    v_mov_b32_dpp v80, v120 quad_perm:[0,1,2,3] row_mask:0xf bank_mask:0x1
    v_mov_b32_dpp v81, v120 row_shr:4 row_mask:0xf bank_mask:0x2
    v_mov_b32_dpp v82, v120 row_shr:8 row_mask:0xf bank_mask:0x4
    v_mov_b32_dpp v83, v120 row_shr:12 row_mask:0xf bank_mask:0x8
    v_mfma_f32_16x16x32_bf16 v[44:47], v[84:87], v[252:255], v[44:47]
    s_add_u32 s82, s82, 0x1000
    buffer_load_dwordx4 v[152:155], v4, s[32:35], s82 offen nt
    s_waitcnt vmcnt(6)
    v_mov_b32_dpp v84, v120 row_shl:4 row_mask:0xf bank_mask:0x1
    v_mov_b32_dpp v85, v120 quad_perm:[0,1,2,3] row_mask:0xf bank_mask:0x2
    v_mov_b32_dpp v86, v120 row_shr:4 row_mask:0xf bank_mask:0x4
    v_mov_b32_dpp v87, v120 row_shr:8 row_mask:0xf bank_mask:0x8
    v_mfma_f32_16x16x32_bf16 v[44:47], v[80:83], v[128:131], v[44:47]
    s_add_u32 s82, s82, 0x1000
    buffer_load_dwordx4 v[156:159], v4, s[32:35], s82 offen nt
    s_waitcnt vmcnt(6)
    v_mov_b32_dpp v80, v120 row_shl:8 row_mask:0xf bank_mask:0x1
    v_mov_b32_dpp v81, v120 row_shl:4 row_mask:0xf bank_mask:0x2
    v_mov_b32_dpp v82, v120 quad_perm:[0,1,2,3] row_mask:0xf bank_mask:0x4
    v_mov_b32_dpp v83, v120 row_shr:4 row_mask:0xf bank_mask:0x8
    v_mfma_f32_16x16x32_bf16 v[44:47], v[84:87], v[132:135], v[44:47]
    s_add_u32 s82, s82, 0x1000
    buffer_load_dwordx4 v[160:163], v4, s[32:35], s82 offen nt
    s_waitcnt vmcnt(6)
    v_mov_b32_dpp v84, v120 row_shl:12 row_mask:0xf bank_mask:0x1
    v_mov_b32_dpp v85, v120 row_shl:8 row_mask:0xf bank_mask:0x2
    v_mov_b32_dpp v86, v120 row_shl:4 row_mask:0xf bank_mask:0x4
    v_mov_b32_dpp v87, v120 quad_perm:[0,1,2,3] row_mask:0xf bank_mask:0x8
    v_mfma_f32_16x16x32_bf16 v[44:47], v[80:83], v[136:139], v[44:47]
    s_add_u32 s82, s82, 0x1000
    buffer_load_dwordx4 v[164:167], v4, s[32:35], s82 offen nt
    s_waitcnt vmcnt(6)
    v_mov_b32_dpp v80, v121 quad_perm:[0,1,2,3] row_mask:0xf bank_mask:0x1
    v_mov_b32_dpp v81, v121 row_shr:4 row_mask:0xf bank_mask:0x2
    v_mov_b32_dpp v82, v121 row_shr:8 row_mask:0xf bank_mask:0x4
    v_mov_b32_dpp v83, v121 row_shr:12 row_mask:0xf bank_mask:0x8
    v_mfma_f32_16x16x32_bf16 v[44:47], v[84:87], v[140:143], v[44:47]
    s_add_u32 s82, s82, 0x1000
    buffer_load_dwordx4 v[168:171], v4, s[32:35], s82 offen nt
    s_waitcnt vmcnt(36)
    s_mov_b32 s86, 20000
L_ml:
    v_cmp_ne_u32 vcc, v34, v22
    s_nop 3
    s_cbranch_vccz L_ml_done
    s_sub_u32 s86, s86, 1
    s_cbranch_scc1 L_ml_done
    buffer_load_dwordx4 v[32:35], v28, s[52:55], 0 offen sc1
    s_waitcnt vmcnt(0)
    s_branch L_ml
L_ml_done:
    v_mov_b32 v26, v32
    s_nop 1
    v_max_f32_dpp v26, v26, v26 row_ror:8 row_mask:0xf bank_mask:0xf
    s_nop 1
    v_max_f32_dpp v26, v26, v26 row_ror:4 row_mask:0xf bank_mask:0xf
    s_nop 1
    v_max_f32_dpp v26, v26, v26 row_ror:2 row_mask:0xf bank_mask:0xf
    s_nop 1
    v_max_f32_dpp v26, v26, v26 row_ror:1 row_mask:0xf bank_mask:0xf
    s_nop 1
    v_max_f32_dpp v26, v26, v26 row_bcast:15 row_mask:0xa bank_mask:0xf
    s_nop 1
    v_max_f32_dpp v26, v26, v26 row_bcast:31 row_mask:0xc bank_mask:0xf
    s_nop 0
    v_readlane_b32 s76, v26, 63
    s_nop 1
    v_subrev_f32 v26, s76, v32
    v_exp_f32 v26, v26
    s_nop 0
    v_mul_f32 v26, v26, v33
    s_nop 1
    v_add_f32_dpp v26, v26, v26 row_ror:8 row_mask:0xf bank_mask:0xf
    s_nop 1
    v_add_f32_dpp v26, v26, v26 row_ror:4 row_mask:0xf bank_mask:0xf
    s_nop 1
    v_add_f32_dpp v26, v26, v26 row_ror:2 row_mask:0xf bank_mask:0xf
    s_nop 1
    v_add_f32_dpp v26, v26, v26 row_ror:1 row_mask:0xf bank_mask:0xf
    s_nop 1
    v_add_f32_dpp v26, v26, v26 row_bcast:15 row_mask:0xa bank_mask:0xf
    s_nop 1
    v_add_f32_dpp v26, v26, v26 row_bcast:31 row_mask:0xc bank_mask:0xf
    s_nop 0
    v_readlane_b32 s77, v26, 63
    v_mov_b32 v26, s84
    v_subrev_f32 v26, s76, v26
    v_exp_f32 v26, v26
    v_rcp_f32 v27, s77
    v_add_f32 v26, v26, v26
    v_mul_f32 v16, v26, v27
    v_mov_b32 v17, v16
    s_waitcnt vmcnt(6)
    v_mov_b32_dpp v84, v121 row_shl:4 row_mask:0xf bank_mask:0x1
    v_mov_b32_dpp v85, v121 quad_perm:[0,1,2,3] row_mask:0xf bank_mask:0x2
    v_mov_b32_dpp v86, v121 row_shr:4 row_mask:0xf bank_mask:0x4
    v_mov_b32_dpp v87, v121 row_shr:8 row_mask:0xf bank_mask:0x8
    v_mfma_f32_16x16x32_bf16 v[44:47], v[80:83], v[144:147], v[44:47]
    s_add_u32 s82, s82, 0x1000
    buffer_load_dwordx4 v[172:175], v4, s[32:35], s82 offen nt
    s_waitcnt vmcnt(6)
    v_mov_b32_dpp v80, v121 row_shl:8 row_mask:0xf bank_mask:0x1
    v_mov_b32_dpp v81, v121 row_shl:4 row_mask:0xf bank_mask:0x2
    v_mov_b32_dpp v82, v121 quad_perm:[0,1,2,3] row_mask:0xf bank_mask:0x4
    v_mov_b32_dpp v83, v121 row_shr:4 row_mask:0xf bank_mask:0x8
    v_mfma_f32_16x16x32_bf16 v[44:47], v[84:87], v[148:151], v[44:47]
    s_add_u32 s82, s82, 0x1000
    buffer_load_dwordx4 v[176:179], v4, s[32:35], s82 offen nt
    s_waitcnt vmcnt(6)
    v_mov_b32_dpp v84, v121 row_shl:12 row_mask:0xf bank_mask:0x1
    v_mov_b32_dpp v85, v121 row_shl:8 row_mask:0xf bank_mask:0x2
    v_mov_b32_dpp v86, v121 row_shl:4 row_mask:0xf bank_mask:0x4
    v_mov_b32_dpp v87, v121 quad_perm:[0,1,2,3] row_mask:0xf bank_mask:0x8
    v_mfma_f32_16x16x32_bf16 v[44:47], v[80:83], v[152:155], v[44:47]
    s_add_u32 s82, s82, 0x1000
    buffer_load_dwordx4 v[180:183], v4, s[32:35], s82 offen nt
    s_waitcnt vmcnt(6)
    v_mov_b32_dpp v80, v122 quad_perm:[0,1,2,3] row_mask:0xf bank_mask:0x1
    v_mov_b32_dpp v81, v122 row_shr:4 row_mask:0xf bank_mask:0x2
    v_mov_b32_dpp v82, v122 row_shr:8 row_mask:0xf bank_mask:0x4
    v_mov_b32_dpp v83, v122 row_shr:12 row_mask:0xf bank_mask:0x8
    v_mfma_f32_16x16x32_bf16 v[44:47], v[84:87], v[156:159], v[44:47]
    s_add_u32 s82, s82, 0x1000
    buffer_load_dwordx4 v[184:187], v4, s[32:35], s82 offen nt
    s_waitcnt vmcnt(6)
    v_mov_b32_dpp v84, v122 row_shl:4 row_mask:0xf bank_mask:0x1
    v_mov_b32_dpp v85, v122 quad_perm:[0,1,2,3] row_mask:0xf bank_mask:0x2
    v_mov_b32_dpp v86, v122 row_shr:4 row_mask:0xf bank_mask:0x4
    v_mov_b32_dpp v87, v122 row_shr:8 row_mask:0xf bank_mask:0x8
    v_mfma_f32_16x16x32_bf16 v[44:47], v[80:83], v[160:163], v[44:47]
    s_add_u32 s82, s82, 0x1000
    buffer_load_dwordx4 v[188:191], v4, s[32:35], s82 offen nt
    s_waitcnt vmcnt(6)
    v_mov_b32_dpp v80, v122 row_shl:8 row_mask:0xf bank_mask:0x1
    v_mov_b32_dpp v81, v122 row_shl:4 row_mask:0xf bank_mask:0x2
    v_mov_b32_dpp v82, v122 quad_perm:[0,1,2,3] row_mask:0xf bank_mask:0x4
    v_mov_b32_dpp v83, v122 row_shr:4 row_mask:0xf bank_mask:0x8
    v_mfma_f32_16x16x32_bf16 v[44:47], v[84:87], v[164:167], v[44:47]
    s_add_u32 s82, s82, 0x1000
    buffer_load_dwordx4 v[192:195], v4, s[32:35], s82 offen nt
    s_waitcnt vmcnt(6)
    v_mov_b32_dpp v84, v122 row_shl:12 row_mask:0xf bank_mask:0x1
    v_mov_b32_dpp v85, v122 row_shl:8 row_mask:0xf bank_mask:0x2
    v_mov_b32_dpp v86, v122 row_shl:4 row_mask:0xf bank_mask:0x4
    v_mov_b32_dpp v87, v122 quad_perm:[0,1,2,3] row_mask:0xf bank_mask:0x8
    v_mfma_f32_16x16x32_bf16 v[44:47], v[80:83], v[168:171], v[44:47]
    s_add_u32 s82, s82, 0x1000
    buffer_load_dwordx4 v[196:199], v4, s[32:35], s82 offen nt
    s_waitcnt vmcnt(6)
    v_mov_b32_dpp v80, v123 quad_perm:[0,1,2,3] row_mask:0xf bank_mask:0x1
    v_mov_b32_dpp v81, v123 row_shr:4 row_mask:0xf bank_mask:0x2
    v_mov_b32_dpp v82, v123 row_shr:8 row_mask:0xf bank_mask:0x4
    v_mov_b32_dpp v83, v123 row_shr:12 row_mask:0xf bank_mask:0x8
    v_mfma_f32_16x16x32_bf16 v[44:47], v[84:87], v[172:175], v[44:47]
    s_add_u32 s82, s82, 0x1000
    buffer_load_dwordx4 v[200:203], v4, s[32:35], s82 offen nt
    s_waitcnt vmcnt(6)
    v_mov_b32_dpp v84, v123 row_shl:4 row_mask:0xf bank_mask:0x1
    v_mov_b32_dpp v85, v123 quad_perm:[0,1,2,3] row_mask:0xf bank_mask:0x2
    v_mov_b32_dpp v86, v123 row_shr:4 row_mask:0xf bank_mask:0x4
    v_mov_b32_dpp v87, v123 row_shr:8 row_mask:0xf bank_mask:0x8
    v_mfma_f32_16x16x32_bf16 v[44:47], v[80:83], v[176:179], v[44:47]
    s_add_u32 s82, s82, 0x1000
    buffer_load_dwordx4 v[204:207], v4, s[32:35], s82 offen nt
    s_waitcnt vmcnt(6)
    v_mov_b32_dpp v80, v123 row_shl:8 row_mask:0xf bank_mask:0x1
    v_mov_b32_dpp v81, v123 row_shl:4 row_mask:0xf bank_mask:0x2
    v_mov_b32_dpp v82, v123 quad_perm:[0,1,2,3] row_mask:0xf bank_mask:0x4
    v_mov_b32_dpp v83, v123 row_shr:4 row_mask:0xf bank_mask:0x8
    v_mfma_f32_16x16x32_bf16 v[44:47], v[84:87], v[180:183], v[44:47]
    s_add_u32 s82, s82, 0x1000
    buffer_load_dwordx4 v[208:211], v4, s[32:35], s82 offen nt
    s_waitcnt vmcnt(6)
    v_mov_b32_dpp v84, v123 row_shl:12 row_mask:0xf bank_mask:0x1
    v_mov_b32_dpp v85, v123 row_shl:8 row_mask:0xf bank_mask:0x2
    v_mov_b32_dpp v86, v123 row_shl:4 row_mask:0xf bank_mask:0x4
    v_mov_b32_dpp v87, v123 quad_perm:[0,1,2,3] row_mask:0xf bank_mask:0x8
    v_mfma_f32_16x16x32_bf16 v[44:47], v[80:83], v[184:187], v[44:47]
    s_add_u32 s82, s82, 0x1000
    buffer_load_dwordx4 v[212:215], v4, s[32:35], s82 offen nt
    s_waitcnt vmcnt(6)
    v_mov_b32_dpp v80, v124 quad_perm:[0,1,2,3] row_mask:0xf bank_mask:0x1
    v_mov_b32_dpp v81, v124 row_shr:4 row_mask:0xf bank_mask:0x2
    v_mov_b32_dpp v82, v124 row_shr:8 row_mask:0xf bank_mask:0x4
    v_mov_b32_dpp v83, v124 row_shr:12 row_mask:0xf bank_mask:0x8
    v_mfma_f32_16x16x32_bf16 v[44:47], v[84:87], v[188:191], v[44:47]
    s_add_u32 s82, s82, 0x1000
    buffer_load_dwordx4 v[216:219], v4, s[32:35], s82 offen nt
    s_waitcnt vmcnt(6)
    v_mov_b32_dpp v84, v124 row_shl:4 row_mask:0xf bank_mask:0x1
    v_mov_b32_dpp v85, v124 quad_perm:[0,1,2,3] row_mask:0xf bank_mask:0x2
    v_mov_b32_dpp v86, v124 row_shr:4 row_mask:0xf bank_mask:0x4
    v_mov_b32_dpp v87, v124 row_shr:8 row_mask:0xf bank_mask:0x8
    v_mfma_f32_16x16x32_bf16 v[44:47], v[80:83], v[192:195], v[44:47]
    s_add_u32 s82, s82, 0x1000
    buffer_load_dwordx4 v[220:223], v4, s[32:35], s82 offen nt
    s_waitcnt vmcnt(6)
    v_mov_b32_dpp v80, v124 row_shl:8 row_mask:0xf bank_mask:0x1
    v_mov_b32_dpp v81, v124 row_shl:4 row_mask:0xf bank_mask:0x2
    v_mov_b32_dpp v82, v124 quad_perm:[0,1,2,3] row_mask:0xf bank_mask:0x4
    v_mov_b32_dpp v83, v124 row_shr:4 row_mask:0xf bank_mask:0x8
    v_mfma_f32_16x16x32_bf16 v[44:47], v[84:87], v[196:199], v[44:47]
    s_add_u32 s82, s82, 0x1000
    buffer_load_dwordx4 v[224:227], v4, s[32:35], s82 offen nt
    s_waitcnt vmcnt(6)
    v_mov_b32_dpp v84, v124 row_shl:12 row_mask:0xf bank_mask:0x1
    v_mov_b32_dpp v85, v124 row_shl:8 row_mask:0xf bank_mask:0x2
    v_mov_b32_dpp v86, v124 row_shl:4 row_mask:0xf bank_mask:0x4
    v_mov_b32_dpp v87, v124 quad_perm:[0,1,2,3] row_mask:0xf bank_mask:0x8
    v_mfma_f32_16x16x32_bf16 v[44:47], v[80:83], v[200:203], v[44:47]
    s_add_u32 s82, s82, 0x1000
    buffer_load_dwordx4 v[228:231], v4, s[32:35], s82 offen nt
    s_waitcnt vmcnt(6)
    v_mov_b32_dpp v80, v125 quad_perm:[0,1,2,3] row_mask:0xf bank_mask:0x1
    v_mov_b32_dpp v81, v125 row_shr:4 row_mask:0xf bank_mask:0x2
    v_mov_b32_dpp v82, v125 row_shr:8 row_mask:0xf bank_mask:0x4
    v_mov_b32_dpp v83, v125 row_shr:12 row_mask:0xf bank_mask:0x8
    v_mfma_f32_16x16x32_bf16 v[44:47], v[84:87], v[204:207], v[44:47]
    s_add_u32 s82, s82, 0x1000
    buffer_load_dwordx4 v[232:235], v4, s[32:35], s82 offen nt
    s_waitcnt vmcnt(6)
    v_mov_b32_dpp v84, v125 row_shl:4 row_mask:0xf bank_mask:0x1
    v_mov_b32_dpp v85, v125 quad_perm:[0,1,2,3] row_mask:0xf bank_mask:0x2
    v_mov_b32_dpp v86, v125 row_shr:4 row_mask:0xf bank_mask:0x4
    v_mov_b32_dpp v87, v125 row_shr:8 row_mask:0xf bank_mask:0x8
    v_mfma_f32_16x16x32_bf16 v[44:47], v[80:83], v[208:211], v[44:47]
    s_add_u32 s82, s82, 0x1000
    buffer_load_dwordx4 v[236:239], v4, s[32:35], s82 offen nt
    s_waitcnt vmcnt(6)
    v_mov_b32_dpp v80, v125 row_shl:8 row_mask:0xf bank_mask:0x1
    v_mov_b32_dpp v81, v125 row_shl:4 row_mask:0xf bank_mask:0x2
    v_mov_b32_dpp v82, v125 quad_perm:[0,1,2,3] row_mask:0xf bank_mask:0x4
    v_mov_b32_dpp v83, v125 row_shr:4 row_mask:0xf bank_mask:0x8
    v_mfma_f32_16x16x32_bf16 v[44:47], v[84:87], v[212:215], v[44:47]
    s_add_u32 s82, s82, 0x1000
    buffer_load_dwordx4 v[240:243], v4, s[32:35], s82 offen nt
    s_waitcnt vmcnt(6)
    v_mov_b32_dpp v84, v125 row_shl:12 row_mask:0xf bank_mask:0x1
    v_mov_b32_dpp v85, v125 row_shl:8 row_mask:0xf bank_mask:0x2
    v_mov_b32_dpp v86, v125 row_shl:4 row_mask:0xf bank_mask:0x4
    v_mov_b32_dpp v87, v125 quad_perm:[0,1,2,3] row_mask:0xf bank_mask:0x8
    v_mfma_f32_16x16x32_bf16 v[44:47], v[80:83], v[216:219], v[44:47]
    s_add_u32 s82, s82, 0x1000
    buffer_load_dwordx4 v[244:247], v4, s[32:35], s82 offen nt
    s_waitcnt vmcnt(6)
    v_mov_b32_dpp v80, v126 quad_perm:[0,1,2,3] row_mask:0xf bank_mask:0x1
    v_mov_b32_dpp v81, v126 row_shr:4 row_mask:0xf bank_mask:0x2
    v_mov_b32_dpp v82, v126 row_shr:8 row_mask:0xf bank_mask:0x4
    v_mov_b32_dpp v83, v126 row_shr:12 row_mask:0xf bank_mask:0x8
    v_mfma_f32_16x16x32_bf16 v[44:47], v[84:87], v[220:223], v[44:47]
    s_add_u32 s82, s82, 0x1000
    buffer_load_dwordx4 v[248:251], v4, s[32:35], s82 offen nt
    s_waitcnt vmcnt(6)
    v_mov_b32_dpp v84, v126 row_shl:4 row_mask:0xf bank_mask:0x1
    v_mov_b32_dpp v85, v126 quad_perm:[0,1,2,3] row_mask:0xf bank_mask:0x2
    v_mov_b32_dpp v86, v126 row_shr:4 row_mask:0xf bank_mask:0x4
    v_mov_b32_dpp v87, v126 row_shr:8 row_mask:0xf bank_mask:0x8
    v_mfma_f32_16x16x32_bf16 v[44:47], v[80:83], v[224:227], v[44:47]
    s_add_u32 s82, s82, 0x1000
    buffer_load_dwordx4 v[252:255], v4, s[32:35], s82 offen nt
    s_waitcnt vmcnt(6)
    v_mov_b32_dpp v80, v126 row_shl:8 row_mask:0xf bank_mask:0x1
    v_mov_b32_dpp v81, v126 row_shl:4 row_mask:0xf bank_mask:0x2
    v_mov_b32_dpp v82, v126 quad_perm:[0,1,2,3] row_mask:0xf bank_mask:0x4
    v_mov_b32_dpp v83, v126 row_shr:4 row_mask:0xf bank_mask:0x8
    v_mfma_f32_16x16x32_bf16 v[44:47], v[84:87], v[228:231], v[44:47]
    s_waitcnt vmcnt(5)
    v_mov_b32_dpp v84, v126 row_shl:12 row_mask:0xf bank_mask:0x1
    v_mov_b32_dpp v85, v126 row_shl:8 row_mask:0xf bank_mask:0x2
    v_mov_b32_dpp v86, v126 row_shl:4 row_mask:0xf bank_mask:0x4
    v_mov_b32_dpp v87, v126 quad_perm:[0,1,2,3] row_mask:0xf bank_mask:0x8
    v_mfma_f32_16x16x32_bf16 v[44:47], v[80:83], v[232:235], v[44:47]
    s_waitcnt vmcnt(4)
    v_mov_b32_dpp v80, v127 quad_perm:[0,1,2,3] row_mask:0xf bank_mask:0x1
    v_mov_b32_dpp v81, v127 row_shr:4 row_mask:0xf bank_mask:0x2
    v_mov_b32_dpp v82, v127 row_shr:8 row_mask:0xf bank_mask:0x4
    v_mov_b32_dpp v83, v127 row_shr:12 row_mask:0xf bank_mask:0x8
    v_mfma_f32_16x16x32_bf16 v[44:47], v[84:87], v[236:239], v[44:47]
    s_movk_i32 s78, 2560
    v_lshlrev_b32 v19, 4, v3
    v_mad_u32_u24 v19, v2, s78, v19
    s_lshl3_add_u32 s77, s81, s72
    s_mul_i32 s77, s77, 1280
    s_cmp_lt_u32 s72, 2
    s_cselect_b32 s77, s77, 1073741824
    buffer_load_dwordx4 a[200:203], v19, s[48:51], s77 offen offset:0 nt
    buffer_load_dwordx4 a[204:207], v19, s[48:51], s77 offen offset:256 nt
    buffer_load_dwordx4 a[208:211], v19, s[48:51], s77 offen offset:512 nt
    buffer_load_dwordx4 a[212:215], v19, s[48:51], s77 offen offset:768 nt
    buffer_load_dwordx4 a[216:219], v19, s[48:51], s77 offen offset:1024 nt
    s_sub_u32 s76, s81, 216
    s_and_b32 s76, s76, 0xffff
    s_lshr_b32 s77, s76, 3
    s_and_b32 s78, s76, 1
    s_lshl1_add_u32 s77, s77, s78
    s_lshl_b32 s77, s77, 7
    s_and_b32 s78, s76, 6
    s_lshl1_add_u32 s24, s78, s77
    v_and_b32 v25, 14, v0
    v_and_b32 v20, 1, v0
    v_lshlrev_b32 v20, 1, v20
    v_lshl_add_u32 v25, v25, 3, v20
    v_cmp_gt_u32 vcc, 16, v0
    buffer_load_ushort v20, v25, s[44:47], s24 offen
    s_nop 0
    v_cndmask_b32 v21, v24, v25, vcc
    s_waitcnt vmcnt(9)
    v_mov_b32_dpp v84, v127 row_shl:4 row_mask:0xf bank_mask:0x1
    v_mov_b32_dpp v85, v127 quad_perm:[0,1,2,3] row_mask:0xf bank_mask:0x2
    v_mov_b32_dpp v86, v127 row_shr:4 row_mask:0xf bank_mask:0x4
    v_mov_b32_dpp v87, v127 row_shr:8 row_mask:0xf bank_mask:0x8
    v_mfma_f32_16x16x32_bf16 v[44:47], v[80:83], v[240:243], v[44:47]
    s_waitcnt vmcnt(8)
    v_mov_b32_dpp v80, v127 row_shl:8 row_mask:0xf bank_mask:0x1
    v_mov_b32_dpp v81, v127 row_shl:4 row_mask:0xf bank_mask:0x2
    v_mov_b32_dpp v82, v127 quad_perm:[0,1,2,3] row_mask:0xf bank_mask:0x4
    v_mov_b32_dpp v83, v127 row_shr:4 row_mask:0xf bank_mask:0x8
    v_mfma_f32_16x16x32_bf16 v[44:47], v[84:87], v[244:247], v[44:47]
    s_waitcnt vmcnt(7)
    v_mov_b32_dpp v84, v127 row_shl:12 row_mask:0xf bank_mask:0x1
    v_mov_b32_dpp v85, v127 row_shl:8 row_mask:0xf bank_mask:0x2
    v_mov_b32_dpp v86, v127 row_shl:4 row_mask:0xf bank_mask:0x4
    v_mov_b32_dpp v87, v127 quad_perm:[0,1,2,3] row_mask:0xf bank_mask:0x8
    v_mfma_f32_16x16x32_bf16 v[44:47], v[80:83], v[248:251], v[44:47]
    s_waitcnt vmcnt(6)
    v_mfma_f32_16x16x32_bf16 v[44:47], v[84:87], v[252:255], v[44:47]
    s_waitcnt vmcnt(63)
    s_nop 6
    v_pk_add_f32 v[44:45], v[44:45], v[46:47]
    v_pk_mul_f32 v[44:45], v[44:45], v[16:17]
    ds_write_b64 v8, v[44:45] offset:2048
    s_cmp_lt_u32 s81, 216
    s_mov_b32 s86, 20000
    s_mov_b64 s[64:65], -1
    s_mov_b64 s[66:67], -1
    s_mov_b64 s[68:69], -1
    s_mov_b64 s[70:71], -1
    s_mov_b32 s77, 40960
    s_mov_b32 s78, 81920
    s_mov_b32 s79, 122880
    s_waitcnt lgkmcnt(0)
    s_barrier
    ds_read_b128 v[96:99], v11 offset:2048
    ds_read_b128 v[100:103], v11 offset:2560
    ds_read_b128 v[104:107], v11 offset:3072
    ds_read_b128 v[108:111], v11 offset:3584
    ds_read_b128 v[112:115], v11 offset:2112
    ds_read_b128 v[116:119], v11 offset:2624
    ds_read_b128 v[120:123], v11 offset:3136
    ds_read_b128 v[124:127], v11 offset:3648
    s_waitcnt lgkmcnt(4)
    v_pk_add_f32 v[96:97], v[96:97], v[100:101]
    v_pk_add_f32 v[98:99], v[98:99], v[102:103]
    v_pk_add_f32 v[104:105], v[104:105], v[108:109]
    v_pk_add_f32 v[106:107], v[106:107], v[110:111]
    v_pk_add_f32 v[96:97], v[96:97], v[104:105]
    v_pk_add_f32 v[98:99], v[98:99], v[106:107]
    v_and_b32 v128, v96, v9
    v_sub_f32 v96, v96, v128
    v_perm_b32 v128, v96, v96, v52
    v_perm_b32 v129, v96, v96, v53
    v_perm_b32 v130, v96, v96, v54
    v_perm_b32 v131, v96, v96, v55
    s_nop 1
    v_mfma_f32_16x16x32_bf16 v[56:59], v[128:131], a[0:3], 0
    v_and_b32 v132, v97, v9
    v_sub_f32 v97, v97, v132
    v_mfma_f32_16x16x32_bf16 v[60:63], v[128:131], a[4:7], 0
    v_perm_b32 v132, v97, v97, v52
    v_perm_b32 v133, v97, v97, v53
    v_mfma_f32_16x16x32_bf16 v[64:67], v[128:131], a[8:11], 0
    v_perm_b32 v134, v97, v97, v54
    v_mfma_f32_16x16x32_bf16 v[68:71], v[128:131], a[12:15], 0
    v_perm_b32 v135, v97, v97, v55
    v_mfma_f32_16x16x32_bf16 v[72:75], v[128:131], a[16:19], 0
    s_nop 0
    v_mfma_f32_16x16x32_bf16 v[56:59], v[132:135], a[20:23], v[56:59]
    v_and_b32 v136, v98, v9
    v_sub_f32 v98, v98, v136
    v_mfma_f32_16x16x32_bf16 v[60:63], v[132:135], a[24:27], v[60:63]
    v_perm_b32 v136, v98, v98, v52
    v_perm_b32 v137, v98, v98, v53
    v_mfma_f32_16x16x32_bf16 v[64:67], v[132:135], a[28:31], v[64:67]
    v_perm_b32 v138, v98, v98, v54
    v_mfma_f32_16x16x32_bf16 v[68:71], v[132:135], a[32:35], v[68:71]
    v_perm_b32 v139, v98, v98, v55
    v_mfma_f32_16x16x32_bf16 v[72:75], v[132:135], a[36:39], v[72:75]
    s_nop 0
    v_mfma_f32_16x16x32_bf16 v[56:59], v[136:139], a[40:43], v[56:59]
    s_waitcnt lgkmcnt(0)
    v_pk_add_f32 v[112:113], v[112:113], v[116:117]
    v_pk_add_f32 v[114:115], v[114:115], v[118:119]
    v_pk_add_f32 v[120:121], v[120:121], v[124:125]
    v_mfma_f32_16x16x32_bf16 v[60:63], v[136:139], a[44:47], v[60:63]
    v_pk_add_f32 v[122:123], v[122:123], v[126:127]
    v_pk_add_f32 v[112:113], v[112:113], v[120:121]
    v_pk_add_f32 v[114:115], v[114:115], v[122:123]
    v_mfma_f32_16x16x32_bf16 v[64:67], v[136:139], a[48:51], v[64:67]
    v_and_b32 v140, v99, v9
    v_sub_f32 v99, v99, v140
    v_perm_b32 v140, v99, v99, v52
    v_mfma_f32_16x16x32_bf16 v[68:71], v[136:139], a[52:55], v[68:71]
    v_perm_b32 v141, v99, v99, v53
    v_perm_b32 v142, v99, v99, v54
    v_perm_b32 v143, v99, v99, v55
    v_mfma_f32_16x16x32_bf16 v[72:75], v[136:139], a[56:59], v[72:75]
    s_nop 0
    v_mfma_f32_16x16x32_bf16 v[56:59], v[140:143], a[60:63], v[56:59]
    v_and_b32 v144, v112, v9
    v_sub_f32 v112, v112, v144
    v_mfma_f32_16x16x32_bf16 v[60:63], v[140:143], a[64:67], v[60:63]
    v_perm_b32 v144, v112, v112, v52
    v_perm_b32 v145, v112, v112, v53
    v_mfma_f32_16x16x32_bf16 v[64:67], v[140:143], a[68:71], v[64:67]
    v_perm_b32 v146, v112, v112, v54
    v_mfma_f32_16x16x32_bf16 v[68:71], v[140:143], a[72:75], v[68:71]
    v_perm_b32 v147, v112, v112, v55
    v_mfma_f32_16x16x32_bf16 v[72:75], v[140:143], a[76:79], v[72:75]
    s_nop 0
    v_mfma_f32_16x16x32_bf16 v[56:59], v[144:147], a[80:83], v[56:59]
    v_and_b32 v148, v113, v9
    v_sub_f32 v113, v113, v148
    v_mfma_f32_16x16x32_bf16 v[60:63], v[144:147], a[84:87], v[60:63]
    v_perm_b32 v148, v113, v113, v52
    v_perm_b32 v149, v113, v113, v53
    v_mfma_f32_16x16x32_bf16 v[64:67], v[144:147], a[88:91], v[64:67]
    v_perm_b32 v150, v113, v113, v54
    v_mfma_f32_16x16x32_bf16 v[68:71], v[144:147], a[92:95], v[68:71]
    v_perm_b32 v151, v113, v113, v55
    v_mfma_f32_16x16x32_bf16 v[72:75], v[144:147], a[96:99], v[72:75]
    s_nop 0
    v_mfma_f32_16x16x32_bf16 v[56:59], v[148:151], a[100:103], v[56:59]
    v_and_b32 v152, v114, v9
    v_sub_f32 v114, v114, v152
    v_mfma_f32_16x16x32_bf16 v[60:63], v[148:151], a[104:107], v[60:63]
    v_perm_b32 v152, v114, v114, v52
    v_perm_b32 v153, v114, v114, v53
    v_mfma_f32_16x16x32_bf16 v[64:67], v[148:151], a[108:111], v[64:67]
    v_perm_b32 v154, v114, v114, v54
    v_mfma_f32_16x16x32_bf16 v[68:71], v[148:151], a[112:115], v[68:71]
    v_perm_b32 v155, v114, v114, v55
    v_mfma_f32_16x16x32_bf16 v[72:75], v[148:151], a[116:119], v[72:75]
    s_nop 0
    v_mfma_f32_16x16x32_bf16 v[56:59], v[152:155], a[120:123], v[56:59]
    v_and_b32 v156, v115, v9
    v_sub_f32 v115, v115, v156
    v_mfma_f32_16x16x32_bf16 v[60:63], v[152:155], a[124:127], v[60:63]
    v_perm_b32 v156, v115, v115, v52
    v_perm_b32 v157, v115, v115, v53
    v_mfma_f32_16x16x32_bf16 v[64:67], v[152:155], a[128:131], v[64:67]
    v_perm_b32 v158, v115, v115, v54
    v_mfma_f32_16x16x32_bf16 v[68:71], v[152:155], a[132:135], v[68:71]
    v_perm_b32 v159, v115, v115, v55
    v_mfma_f32_16x16x32_bf16 v[72:75], v[152:155], a[136:139], v[72:75]
    s_nop 0
    v_mfma_f32_16x16x32_bf16 v[56:59], v[156:159], a[140:143], v[56:59]
    v_mfma_f32_16x16x32_bf16 v[60:63], v[156:159], a[144:147], v[60:63]
    v_mfma_f32_16x16x32_bf16 v[64:67], v[156:159], a[148:151], v[64:67]
    v_mfma_f32_16x16x32_bf16 v[68:71], v[156:159], a[152:155], v[68:71]
    v_mfma_f32_16x16x32_bf16 v[72:75], v[156:159], a[156:159], v[72:75]
    s_waitcnt vmcnt(1)
    v_mfma_f32_16x16x32_bf16 v[56:59], v[76:79], a[200:203], v[56:59]
    v_mfma_f32_16x16x32_bf16 v[60:63], v[76:79], a[204:207], v[60:63]
    v_mfma_f32_16x16x32_bf16 v[64:67], v[76:79], a[208:211], v[64:67]
    v_mfma_f32_16x16x32_bf16 v[68:71], v[76:79], a[212:215], v[68:71]
    v_mfma_f32_16x16x32_bf16 v[72:75], v[76:79], a[216:219], v[72:75]
    s_nop 3
    v_pk_add_f32 v[56:57], v[56:57], v[58:59]
    ds_write_b64 v5, v[56:57] offset:8704
    v_pk_add_f32 v[60:61], v[60:61], v[62:63]
    ds_write_b64 v5, v[60:61] offset:9216
    v_pk_add_f32 v[64:65], v[64:65], v[66:67]
    ds_write_b64 v5, v[64:65] offset:9728
    v_pk_add_f32 v[68:69], v[68:69], v[70:71]
    ds_write_b64 v5, v[68:69] offset:10240
    v_pk_add_f32 v[72:73], v[72:73], v[74:75]
    ds_write_b64 v5, v[72:73] offset:10752
    s_waitcnt lgkmcnt(0)
    s_barrier
    ds_read_b128 v[96:99], v13 offset:8704
    ds_read_b128 v[100:103], v13 offset:11264
    ds_read_b128 v[104:107], v13 offset:13824
    ds_read_b128 v[108:111], v13 offset:16384
    s_waitcnt lgkmcnt(2)
    v_pk_add_f32 v[96:97], v[96:97], v[100:101]
    v_pk_add_f32 v[98:99], v[98:99], v[102:103]
    s_waitcnt lgkmcnt(0)
    v_pk_add_f32 v[104:105], v[104:105], v[108:109]
    v_pk_add_f32 v[106:107], v[106:107], v[110:111]
    v_pk_add_f32 v[96:97], v[96:97], v[104:105]
    v_pk_add_f32 v[98:99], v[98:99], v[106:107]
    v_perm_b32 v96, v96, v22, s60
    v_perm_b32 v97, v97, v22, s61
    v_perm_b32 v98, v98, v22, s62
    v_perm_b32 v99, v99, v22, s63
    buffer_store_dwordx4 v[96:99], v6, s[52:55], 0 offen sc1
    s_nop 0
    s_cbranch_scc1 L_fin
L_red:
    s_mov_b64 exec, s[64:65]
    buffer_load_dwordx4 v[128:131], v12, s[52:55], 0 offen sc1
    s_mov_b64 exec, s[66:67]
    buffer_load_dwordx4 v[132:135], v12, s[52:55], s77 offen sc1
    s_mov_b64 exec, s[68:69]
    buffer_load_dwordx4 v[136:139], v12, s[52:55], s78 offen sc1
    s_mov_b64 exec, s[70:71]
    buffer_load_dwordx4 v[140:143], v12, s[52:55], s79 offen sc1
    s_mov_b64 exec, -1
    s_sub_u32 s86, s86, 1
    s_cbranch_scc1 L_red_done
    s_waitcnt vmcnt(3)
    v_perm_b32 v26, v129, v128, s3
    v_perm_b32 v27, v131, v130, s3
    v_lshl_or_b32 v26, v27, 16, v26
    v_cmp_ne_u32 s[64:65], v26, v22
    s_waitcnt vmcnt(2)
    v_perm_b32 v28, v133, v132, s3
    v_perm_b32 v29, v135, v134, s3
    v_lshl_or_b32 v28, v29, 16, v28
    v_cmp_ne_u32 s[66:67], v28, v22
    s_waitcnt vmcnt(1)
    v_perm_b32 v26, v137, v136, s3
    v_perm_b32 v27, v139, v138, s3
    v_lshl_or_b32 v26, v27, 16, v26
    v_cmp_ne_u32 s[68:69], v26, v22
    s_waitcnt vmcnt(0)
    v_perm_b32 v28, v141, v140, s3
    v_perm_b32 v29, v143, v142, s3
    v_lshl_or_b32 v28, v29, 16, v28
    v_cmp_ne_u32 s[70:71], v28, v22
    s_or_b64 vcc, s[64:65], s[66:67]
    s_or_b64 vcc, vcc, s[68:69]
    s_or_b64 vcc, vcc, s[70:71]
    s_nop 0
    s_cbranch_scc1 L_red
L_red_done:
    v_pk_add_f32 v[144:145], v[128:129], v[132:133]
    v_pk_add_f32 v[152:153], v[136:137], v[140:141]
    v_pk_add_f32 v[146:147], v[130:131], v[134:135]
    v_pk_add_f32 v[154:155], v[138:139], v[142:143]
    v_pk_add_f32 v[144:145], v[144:145], v[152:153]
    v_pk_add_f32 v[146:147], v[146:147], v[154:155]
    s_nop 1
    v_permlane32_swap_b32 v144, v146
    v_permlane32_swap_b32 v145, v147
    v_pk_add_f32 v[144:145], v[144:145], v[146:147]
    s_nop 1
    v_permlane16_swap_b32 v144, v145
    v_add_f32 v144, v144, v145
    v_and_b32 v26, 3, v0
    v_lshl_add_u32 v26, v26, 2, v2
    v_add_f32_dpp v144, v144, v144 row_ror:4 row_mask:0xf bank_mask:0xf
    v_lshlrev_b32 v26, 4, v26
    s_lshl_b32 s78, s72, 2
    v_add_f32_dpp v144, v144, v144 row_ror:8 row_mask:0xf bank_mask:0xf
    v_add_u32 v26, s78, v26
    ds_write_b32 v26, v144 offset:8192
    v_lshlrev_b32 v27, 4, v3
    v_lshlrev_b32 v20, 16, v20
    s_waitcnt lgkmcnt(0)
    s_barrier
    ds_read_b128 v[144:147], v27 offset:8192
    s_waitcnt lgkmcnt(0)
    v_pk_add_f32 v[144:145], v[144:145], v[146:147]
    v_add_f32 v144, v144, v145
    v_add_f32 v144, v144, v20
    v_cvt_pk_bf16_f32 v144, v144, v144
    buffer_store_short v144, v21, s[56:59], s24 offen
    v_add_u32 v23, 1, v23
    v_lshlrev_b32 v27, 22, v0
    s_lshl_b32 s76, s24, 17
    s_add_u32 s76, s76, 1064960
    buffer_store_dword v23, v27, s[52:55], s76 offen sc1
L_fin:
L_end:
    s_endpgm
.section .rodata,"a"
.p2align 6
.amdhsa_kernel parallel_sum__mha_block_cached__swiglu_ffn__decode_kernel
  .amdhsa_next_free_vgpr 512
  .amdhsa_next_free_sgpr 102
  .amdhsa_accum_offset 256
  .amdhsa_group_segment_fixed_size 0
  .amdhsa_kernarg_size 96
  .amdhsa_user_sgpr_count 2
  .amdhsa_user_sgpr_kernarg_segment_ptr 1
  .amdhsa_system_sgpr_workgroup_id_x 1
.end_amdhsa_kernel
```
